```python
import torch

def _softmax(x, axis=-1):
    return torch.softmax(x, dim=axis)
def _gelu(x):
    return torch.nn.functional.gelu(x, approximate="tanh")
def _silu(x):
    return torch.nn.functional.silu(x)
def _sigmoid(x):
    return torch.sigmoid(x)
def _layernorm(x, axis=-1, eps=1e-5):
    m = x.mean(dim=axis, keepdim=True)
    v = x.var(dim=axis, keepdim=True, unbiased=False)
    return (x - m) / torch.sqrt(v + eps)
def _scatter_add(tgt, idx, src, axis=0):
    return tgt.clone().index_add_(axis, idx, src)
def _segment_sum(src, seg, n):
    out = torch.zeros((n,) + src.shape[1:], dtype=src.dtype)
    return out.index_add_(0, seg, src)
def _pad(x, pw):
    flat = tuple(v for pair in reversed(pw) for v in pair)
    return torch.nn.functional.pad(x, flat)

kernel_name = 'sequential_preLN__grouped_kv_mqa__glu_gated_bilinear__prompt'

def setup_inputs():

    _w = (lambda a: (lambda t: t.to(torch.bfloat16) if t.is_floating_point() else t)(torch.as_tensor(a)))
    def _A_setup():
        B, S, D, H = 1, 2048, 640, 32
        Dh = D // H
        return {
            "x": _w((lambda *s: torch.randn(*s, dtype=torch.bfloat16) * 0.05)(B, S, D)),
            "wq": _w((lambda *s: torch.randn(*s, dtype=torch.bfloat16) * 0.05)(D, H * Dh)),
            "wk": _w((lambda *s: torch.randn(*s, dtype=torch.bfloat16) * 0.05)(D, Dh)),
            "wv": _w((lambda *s: torch.randn(*s, dtype=torch.bfloat16) * 0.05)(D, Dh)),
            "wo": _w((lambda *s: torch.randn(*s, dtype=torch.bfloat16) * 0.05)(H * Dh, D)),
        }
    _A_in = _A_setup()

    def _B_setup():
        B, S, D, F = 1, 2048, 640, 1728
        return {
            "x": _w((lambda *s: torch.randn(*s, dtype=torch.bfloat16) * 0.05)(B, S, D)),
            "w_gate": _w((lambda *s: torch.randn(*s, dtype=torch.bfloat16) * 0.8)(D, F) * (D ** -0.5)),
            "w_up": _w((lambda *s: torch.randn(*s, dtype=torch.bfloat16) * 0.8)(D, F) * (D ** -0.5)),
            "w_down": _w((lambda *s: torch.randn(*s, dtype=torch.bfloat16) * 0.8)(F, D) * (F ** -0.5)),
        }
    _B_in = _B_setup()

    return {
        "A_x": _A_in["x"],
        "A_wq": _A_in["wq"],
        "A_wk": _A_in["wk"],
        "A_wv": _A_in["wv"],
        "A_wo": _A_in["wo"],
        "B_x": _B_in["x"],
        "B_w_gate": _B_in["w_gate"],
        "B_w_up": _B_in["w_up"],
        "B_w_down": _B_in["w_down"],
    }

def reference(A_x, A_wq, A_wk, A_wv, A_wo, B_x, B_w_gate, B_w_up, B_w_down):
    def _A_ref(x, wq, wk, wv, wo):
        B, S, D = x.shape
        H = 32
        Dh = D // H
        q = (lambda x, *d: x.permute(*d))((x @ wq).reshape(B, S, H, Dh), 0, 2, 1, 3)
        k = x @ wk
        v = x @ wv
        scores = torch.einsum("bhqd,bkd->bhqk", q, k) * (Dh ** -0.5)
        p = _softmax(scores, axis=-1)
        o = torch.einsum("bhqk,bkd->bhqd", p, v)
        return (lambda x, *d: x.permute(*d))(o, 0, 2, 1, 3).reshape(B, S, H * Dh) @ wo

    def _B_ref(x, w_gate, w_up, w_down):
        g = torch.einsum("bsd,df->bsf", x, w_gate)
        u = torch.einsum("bsd,df->bsf", x, w_up)
        h = g * u
        return torch.einsum("bsf,fd->bsd", h, w_down)

    x = A_x
    h = x + _A_ref(_layernorm(x, axis=-1), A_wq, A_wk, A_wv, A_wo)
    h2 = h + _B_ref(_layernorm(h, axis=-1), B_w_gate, B_w_up, B_w_down)
    return h2
```

```asm
; @launch kernel=k1_qkv_kernel grid=(256,1,1) block=(384,1,1) lds=163840
; @launch kernel=k2_attn_kernel grid=(366,1,1) block=(512,1,1) lds=65536
; @launch kernel=k3_wo_kernel grid=(256,1,1) block=(384,1,1) lds=147456
; @launch kernel=k4_gateup_kernel grid=(256,1,1) block=(640,1,1) lds=136192
; @launch kernel=k5_down_kernel grid=(256,1,1) block=(384,1,1) lds=147456
.amdgcn_target "amdgcn-amd-amdhsa--gfx950"
.text
.globl k1_qkv_kernel
.p2align 8
.type k1_qkv_kernel,@function
k1_qkv_kernel:
  s_cmp_ge_u32 s2, 256
  s_cbranch_scc1 L_k1_qkv_kernel_end
  s_load_dwordx2 s[44:45], s[0:1], 88
  s_load_dwordx2 s[42:43], s[0:1], 8
  s_load_dwordx2 s[40:41], s[0:1], 0
  s_load_dwordx2 s[46:47], s[0:1], 16
  s_load_dwordx2 s[48:49], s[0:1], 24
  v_and_b32 v1, 63, v0
  v_lshrrev_b32 v22, 6, v0
  v_lshrrev_b32 v2, 4, v1
  v_readfirstlane_b32 s24, v22
  v_and_b32 v3, 15, v1
  s_and_b32 s33, s2, 7
  s_lshr_b32 s26, s2, 3
  s_lshl_b32 s25, s33, 2
  s_lshr_b32 s33, s26, 3
  s_add_u32 s25, s25, s33
  s_and_b32 s26, s26, 7
  s_cmp_eq_u32 s24, 4
  s_cbranch_scc1 L_k1_qkv_kernel_1
  s_cmp_eq_u32 s24, 5
  s_cbranch_scc1 L_k1_qkv_kernel_2
  s_waitcnt lgkmcnt(0)
  s_mov_b32 s4, s40
  s_mov_b32 s5, s41
  s_mov_b32 s6, 0x280000
  s_mov_b32 s7, 0x20000
  s_mov_b32 s8, s42
  s_mov_b32 s9, s43
  s_mov_b32 s10, 0xc8000
  s_mov_b32 s11, 0x20000
  s_bitcmp1_b32 s26, 1
  s_cselect_b32 s12, s48, s46
  s_cselect_b32 s13, s49, s47
  s_cmp_lt_u32 s26, 4
  s_cselect_b32 s14, 25600, 0
  s_mov_b32 s15, 0x20000
  s_mov_b32 s16, s44
  s_mov_b32 s17, s45
  s_mov_b32 s18, 0x280000
  s_mov_b32 s19, 0x20000
  s_add_u32 s20, s44, 0x280000
  s_addc_u32 s21, s45, 0
  s_mov_b32 s22, 0x40200
  s_mov_b32 s23, 0x20000
  s_and_b32 s33, s24, 1
  s_lshl_b32 s33, s33, 13
  v_xor_b32 v22, v2, v3
  v_lshlrev_b32 v23, 8, v3
  v_add_u32 v23, s33, v23
  v_xor_b32 v24, 0, v22
  v_lshl_add_u32 v14, v24, 4, v23
  v_xor_b32 v24, 4, v22
  v_lshl_add_u32 v15, v24, 4, v23
  v_xor_b32 v24, 8, v22
  v_lshl_add_u32 v16, v24, 4, v23
  v_xor_b32 v24, 12, v22
  v_lshl_add_u32 v17, v24, 4, v23
  v_lshrrev_b32 v22, 2, v1
  v_and_b32 v22, 3, v22
  v_and_b32 v23, 1, v2
  v_lshlrev_b32 v23, 2, v23
  v_xor_b32 v22, v22, v23
  v_lshl_add_u32 v22, v2, 3, v22
  v_xor_b32 v23, 4, v22
  v_and_b32 v24, 3, v1
  v_lshlrev_b32 v24, 3, v24
  v_mul_u32_u24 v18, 160, v22
  v_mul_u32_u24 v19, 160, v23
  v_add3_u32 v18, v18, v24, 0
  v_add_u32 v19, v19, v24
  v_add_u32 v18, 16384, v18
  v_add_u32 v19, 16384, v19
  v_lshl_add_u32 v20, v22, 5, v24
  v_lshl_add_u32 v21, v23, 5, v24
  v_add_u32 v20, 36864, v20
  v_add_u32 v21, 36864, v21
  s_lshl_b32 s33, s25, 6
  s_and_b32 s34, s24, 1
  s_lshl_b32 s34, s34, 5
  s_add_u32 s33, s33, s34
  v_add_u32 v22, s33, v3
  v_mul_u32_u24 v128, 1280, v22
  s_mul_i32 s33, s26, 160
  s_lshr_b32 s34, s24, 1
  s_mul_i32 s34, s34, 96
  s_add_u32 s33, s33, s34
  v_lshlrev_b32 v22, 3, v2
  v_add3_u32 v128, v128, v22, s33
  v_mov_b32 v72, 0
  v_mov_b32 v73, 0
  v_mov_b32 v74, 0
  v_mov_b32 v75, 0
  v_mov_b32 v76, 0
  v_mov_b32 v77, 0
  v_mov_b32 v78, 0
  v_mov_b32 v79, 0
  v_mov_b32 v80, 0
  v_mov_b32 v81, 0
  v_mov_b32 v82, 0
  v_mov_b32 v83, 0
  v_mov_b32 v84, 0
  v_mov_b32 v85, 0
  v_mov_b32 v86, 0
  v_mov_b32 v87, 0
  v_mov_b32 v88, 0
  v_mov_b32 v89, 0
  v_mov_b32 v90, 0
  v_mov_b32 v91, 0
  v_mov_b32 v92, 0
  v_mov_b32 v93, 0
  v_mov_b32 v94, 0
  v_mov_b32 v95, 0
  v_mov_b32 v96, 0
  v_mov_b32 v97, 0
  v_mov_b32 v98, 0
  v_mov_b32 v99, 0
  v_mov_b32 v100, 0
  v_mov_b32 v101, 0
  v_mov_b32 v102, 0
  v_mov_b32 v103, 0
  v_mov_b32 v104, 0
  v_mov_b32 v105, 0
  v_mov_b32 v106, 0
  v_mov_b32 v107, 0
  v_mov_b32 v108, 0x3f803f80
  v_mov_b32 v109, 0x3f803f80
  v_mov_b32 v110, 0x3f803f80
  v_mov_b32 v111, 0x3f803f80
  v_mov_b32 v136, 0
  v_mov_b32 v137, 0
  v_mov_b32 v138, 0
  v_mov_b32 v139, 0
  v_mov_b32 v140, 0
  v_mov_b32 v141, 0
  v_mov_b32 v142, 0
  v_mov_b32 v143, 0
  s_cmp_ge_u32 s24, 2
  s_cbranch_scc1 L_k1_qkv_kernel_3
  s_mov_b32 s56, 0
  s_mov_b32 s57, 0
  s_mov_b32 s59, 40960
L_k1_qkv_kernel_4:
  s_barrier
  v_add_u32 v14, s57, v14
  v_add_u32 v15, s57, v15
  v_add_u32 v16, s57, v16
  v_add_u32 v17, s57, v17
  v_add_u32 v18, s57, v18
  v_add_u32 v19, s57, v19
  v_add_u32 v20, s57, v20
  v_add_u32 v21, s57, v21
  ds_read_b128 v[32:35], v14 offset:0
  ds_read_b128 v[36:39], v14 offset:4096
  ds_read_b64_tr_b16 v[48:49], v18 offset:0
  ds_read_b64_tr_b16 v[50:51], v19 offset:0
  ds_read_b64_tr_b16 v[52:53], v18 offset:32
  ds_read_b64_tr_b16 v[54:55], v19 offset:32
  ds_read_b64_tr_b16 v[56:57], v18 offset:64
  ds_read_b64_tr_b16 v[58:59], v19 offset:64
  ds_read_b128 v[40:43], v15 offset:0
  ds_read_b128 v[44:47], v15 offset:4096
  ds_read_b64_tr_b16 v[60:61], v18 offset:5120
  ds_read_b64_tr_b16 v[62:63], v19 offset:5120
  ds_read_b64_tr_b16 v[64:65], v18 offset:5152
  ds_read_b64_tr_b16 v[66:67], v19 offset:5152
  ds_read_b64_tr_b16 v[68:69], v18 offset:5184
  ds_read_b64_tr_b16 v[70:71], v19 offset:5184
  s_waitcnt lgkmcnt(8)
  v_mfma_f32_16x16x32_bf16 v[72:75], v[48:51], v[32:35], v[72:75]
  v_mfma_f32_16x16x32_bf16 v[76:79], v[48:51], v[36:39], v[76:79]
  v_mfma_f32_16x16x32_bf16 v[96:99], v[48:51], v[108:111], v[96:99]
  v_mfma_f32_16x16x32_bf16 v[80:83], v[52:55], v[32:35], v[80:83]
  v_mfma_f32_16x16x32_bf16 v[84:87], v[52:55], v[36:39], v[84:87]
  v_mfma_f32_16x16x32_bf16 v[100:103], v[52:55], v[108:111], v[100:103]
  v_mfma_f32_16x16x32_bf16 v[88:91], v[56:59], v[32:35], v[88:91]
  v_mfma_f32_16x16x32_bf16 v[92:95], v[56:59], v[36:39], v[92:95]
  v_mfma_f32_16x16x32_bf16 v[104:107], v[56:59], v[108:111], v[104:107]
  v_mfma_f32_16x16x32_bf16 v[136:139], v[108:111], v[32:35], v[136:139]
  v_mfma_f32_16x16x32_bf16 v[140:143], v[32:35], v[32:35], v[140:143]
  ds_read_b128 v[32:35], v16 offset:0
  ds_read_b128 v[36:39], v16 offset:4096
  ds_read_b64_tr_b16 v[48:49], v18 offset:10240
  ds_read_b64_tr_b16 v[50:51], v19 offset:10240
  ds_read_b64_tr_b16 v[52:53], v18 offset:10272
  ds_read_b64_tr_b16 v[54:55], v19 offset:10272
  ds_read_b64_tr_b16 v[56:57], v18 offset:10304
  ds_read_b64_tr_b16 v[58:59], v19 offset:10304
  s_waitcnt lgkmcnt(8)
  v_mfma_f32_16x16x32_bf16 v[72:75], v[60:63], v[40:43], v[72:75]
  v_mfma_f32_16x16x32_bf16 v[76:79], v[60:63], v[44:47], v[76:79]
  v_mfma_f32_16x16x32_bf16 v[96:99], v[60:63], v[108:111], v[96:99]
  v_mfma_f32_16x16x32_bf16 v[80:83], v[64:67], v[40:43], v[80:83]
  v_mfma_f32_16x16x32_bf16 v[84:87], v[64:67], v[44:47], v[84:87]
  v_mfma_f32_16x16x32_bf16 v[100:103], v[64:67], v[108:111], v[100:103]
  v_mfma_f32_16x16x32_bf16 v[88:91], v[68:71], v[40:43], v[88:91]
  v_mfma_f32_16x16x32_bf16 v[92:95], v[68:71], v[44:47], v[92:95]
  v_mfma_f32_16x16x32_bf16 v[104:107], v[68:71], v[108:111], v[104:107]
  v_mfma_f32_16x16x32_bf16 v[136:139], v[108:111], v[40:43], v[136:139]
  v_mfma_f32_16x16x32_bf16 v[140:143], v[40:43], v[40:43], v[140:143]
  ds_read_b128 v[40:43], v17 offset:0
  ds_read_b128 v[44:47], v17 offset:4096
  ds_read_b64_tr_b16 v[60:61], v18 offset:15360
  ds_read_b64_tr_b16 v[62:63], v19 offset:15360
  ds_read_b64_tr_b16 v[64:65], v18 offset:15392
  ds_read_b64_tr_b16 v[66:67], v19 offset:15392
  ds_read_b64_tr_b16 v[68:69], v18 offset:15424
  ds_read_b64_tr_b16 v[70:71], v19 offset:15424
  s_waitcnt lgkmcnt(8)
  v_mfma_f32_16x16x32_bf16 v[72:75], v[48:51], v[32:35], v[72:75]
  v_mfma_f32_16x16x32_bf16 v[76:79], v[48:51], v[36:39], v[76:79]
  v_mfma_f32_16x16x32_bf16 v[96:99], v[48:51], v[108:111], v[96:99]
  v_mfma_f32_16x16x32_bf16 v[80:83], v[52:55], v[32:35], v[80:83]
  v_mfma_f32_16x16x32_bf16 v[84:87], v[52:55], v[36:39], v[84:87]
  v_mfma_f32_16x16x32_bf16 v[100:103], v[52:55], v[108:111], v[100:103]
  v_mfma_f32_16x16x32_bf16 v[88:91], v[56:59], v[32:35], v[88:91]
  v_mfma_f32_16x16x32_bf16 v[92:95], v[56:59], v[36:39], v[92:95]
  v_mfma_f32_16x16x32_bf16 v[104:107], v[56:59], v[108:111], v[104:107]
  v_mfma_f32_16x16x32_bf16 v[136:139], v[108:111], v[32:35], v[136:139]
  v_mfma_f32_16x16x32_bf16 v[140:143], v[32:35], v[32:35], v[140:143]
  s_waitcnt lgkmcnt(0)
  v_mfma_f32_16x16x32_bf16 v[72:75], v[60:63], v[40:43], v[72:75]
  v_mfma_f32_16x16x32_bf16 v[76:79], v[60:63], v[44:47], v[76:79]
  v_mfma_f32_16x16x32_bf16 v[96:99], v[60:63], v[108:111], v[96:99]
  v_mfma_f32_16x16x32_bf16 v[80:83], v[64:67], v[40:43], v[80:83]
  v_mfma_f32_16x16x32_bf16 v[84:87], v[64:67], v[44:47], v[84:87]
  v_mfma_f32_16x16x32_bf16 v[100:103], v[64:67], v[108:111], v[100:103]
  v_mfma_f32_16x16x32_bf16 v[88:91], v[68:71], v[40:43], v[88:91]
  v_mfma_f32_16x16x32_bf16 v[92:95], v[68:71], v[44:47], v[92:95]
  v_mfma_f32_16x16x32_bf16 v[104:107], v[68:71], v[108:111], v[104:107]
  v_mfma_f32_16x16x32_bf16 v[136:139], v[108:111], v[40:43], v[136:139]
  v_mfma_f32_16x16x32_bf16 v[140:143], v[40:43], v[40:43], v[140:143]
  s_add_u32 s56, s56, 1
  s_and_b32 s33, s56, 3
  s_cmp_eq_u32 s33, 0
  s_cselect_b32 s57, -122880, s59
  s_cmp_lt_u32 s56, 5
  s_cbranch_scc1 L_k1_qkv_kernel_4
  s_waitcnt vmcnt(0)
  s_nop 7
  s_nop 7
  v_and_b32 v22, 3, v3
  v_cmp_eq_u32 vcc, 1, v22
  v_cndmask_b32 v113, v140, v141, vcc
  v_cmp_eq_u32 vcc, 2, v22
  v_cndmask_b32 v113, v113, v142, vcc
  v_cmp_eq_u32 vcc, 3, v22
  v_cndmask_b32 v113, v113, v143, vcc
  v_lshrrev_b32 v22, 2, v3
  v_cmp_eq_u32 vcc, v22, v2
  v_cndmask_b32 v113, 0, v113, vcc
  v_cmp_eq_u32 vcc, 0, v2
  v_cndmask_b32 v112, 0, v136, vcc
  v_mov_b32 v22, v112
  v_mov_b32 v23, v112
  s_nop 1
  v_permlane16_swap_b32 v22, v23
  s_nop 1
  v_add_f32 v112, v22, v23
  v_mov_b32 v22, v112
  v_mov_b32 v23, v112
  s_nop 1
  v_permlane32_swap_b32 v22, v23
  s_nop 1
  v_add_f32 v112, v22, v23
  v_mov_b32 v22, v113
  v_mov_b32 v23, v113
  s_nop 1
  v_permlane16_swap_b32 v22, v23
  s_nop 1
  v_add_f32 v113, v22, v23
  v_mov_b32 v22, v113
  v_mov_b32 v23, v113
  s_nop 1
  v_permlane32_swap_b32 v22, v23
  s_nop 1
  v_add_f32 v113, v22, v23
  v_mul_f32 v24, 0x3acccccd, v112
  v_mul_f32 v22, 0x3acccccd, v113
  v_fma_f32 v22, -v24, v24, v22
  v_max_f32 v22, 0, v22
  v_add_f32 v22, 0x3727c5ac, v22
  v_rsq_f32 v25, v22
  s_nop 0
  s_and_b32 s33, s24, 1
  s_lshl_b32 s33, s33, 8
  v_lshlrev_b32 v26, 3, v3
  v_add_u32 v26, s33, v26
  s_barrier
  ds_write_b64 v26, v[24:25] offset:0
  s_waitcnt lgkmcnt(0)
  s_barrier
  ds_read_b64 v[28:29], v26
  ds_read_b64 v[30:31], v26 offset:128
  s_waitcnt lgkmcnt(0)
  v_mul_f32 v129, 0x3ea52b5c, v29
  v_mul_f32 v130, 0x3ea52b5c, v31
  v_fma_f32 v72, -v28, v96, v72
  v_mul_f32 v72, v72, v129
  v_fma_f32 v73, -v28, v97, v73
  v_mul_f32 v73, v73, v129
  v_fma_f32 v74, -v28, v98, v74
  v_mul_f32 v74, v74, v129
  v_fma_f32 v75, -v28, v99, v75
  v_mul_f32 v75, v75, v129
  v_fma_f32 v76, -v30, v96, v76
  v_mul_f32 v76, v76, v130
  v_fma_f32 v77, -v30, v97, v77
  v_mul_f32 v77, v77, v130
  v_fma_f32 v78, -v30, v98, v78
  v_mul_f32 v78, v78, v130
  v_fma_f32 v79, -v30, v99, v79
  v_mul_f32 v79, v79, v130
  v_cvt_pk_bf16_f32 v72, v72, v73
  v_cvt_pk_bf16_f32 v73, v74, v75
  s_mov_b32 s33, 0
  buffer_store_dwordx2 v[72:73], v128, s[16:19], s33 offen offset:0
  v_cvt_pk_bf16_f32 v76, v76, v77
  v_cvt_pk_bf16_f32 v77, v78, v79
  s_mov_b32 s33, 20480
  buffer_store_dwordx2 v[76:77], v128, s[16:19], s33 offen offset:0
  v_fma_f32 v80, -v28, v100, v80
  v_mul_f32 v80, v80, v129
  v_fma_f32 v81, -v28, v101, v81
  v_mul_f32 v81, v81, v129
  v_fma_f32 v82, -v28, v102, v82
  v_mul_f32 v82, v82, v129
  v_fma_f32 v83, -v28, v103, v83
  v_mul_f32 v83, v83, v129
  v_fma_f32 v84, -v30, v100, v84
  v_mul_f32 v84, v84, v130
  v_fma_f32 v85, -v30, v101, v85
  v_mul_f32 v85, v85, v130
  v_fma_f32 v86, -v30, v102, v86
  v_mul_f32 v86, v86, v130
  v_fma_f32 v87, -v30, v103, v87
  v_mul_f32 v87, v87, v130
  v_cvt_pk_bf16_f32 v80, v80, v81
  v_cvt_pk_bf16_f32 v81, v82, v83
  s_mov_b32 s33, 0
  buffer_store_dwordx2 v[80:81], v128, s[16:19], s33 offen offset:32
  v_cvt_pk_bf16_f32 v84, v84, v85
  v_cvt_pk_bf16_f32 v85, v86, v87
  s_mov_b32 s33, 20480
  buffer_store_dwordx2 v[84:85], v128, s[16:19], s33 offen offset:32
  v_fma_f32 v88, -v28, v104, v88
  v_mul_f32 v88, v88, v129
  v_fma_f32 v89, -v28, v105, v89
  v_mul_f32 v89, v89, v129
  v_fma_f32 v90, -v28, v106, v90
  v_mul_f32 v90, v90, v129
  v_fma_f32 v91, -v28, v107, v91
  v_mul_f32 v91, v91, v129
  v_fma_f32 v92, -v30, v104, v92
  v_mul_f32 v92, v92, v130
  v_fma_f32 v93, -v30, v105, v93
  v_mul_f32 v93, v93, v130
  v_fma_f32 v94, -v30, v106, v94
  v_mul_f32 v94, v94, v130
  v_fma_f32 v95, -v30, v107, v95
  v_mul_f32 v95, v95, v130
  v_cvt_pk_bf16_f32 v88, v88, v89
  v_cvt_pk_bf16_f32 v89, v90, v91
  s_mov_b32 s33, 0
  buffer_store_dwordx2 v[88:89], v128, s[16:19], s33 offen offset:64
  v_cvt_pk_bf16_f32 v92, v92, v93
  v_cvt_pk_bf16_f32 v93, v94, v95
  s_mov_b32 s33, 20480
  buffer_store_dwordx2 v[92:93], v128, s[16:19], s33 offen offset:64
  s_endpgm
L_k1_qkv_kernel_3:
  s_mov_b32 s56, 0
  s_mov_b32 s57, 0
  s_mov_b32 s59, 40960
L_k1_qkv_kernel_5:
  s_barrier
  v_add_u32 v14, s57, v14
  v_add_u32 v15, s57, v15
  v_add_u32 v16, s57, v16
  v_add_u32 v17, s57, v17
  v_add_u32 v18, s57, v18
  v_add_u32 v19, s57, v19
  v_add_u32 v20, s57, v20
  v_add_u32 v21, s57, v21
  ds_read_b128 v[32:35], v14 offset:0
  ds_read_b128 v[36:39], v14 offset:4096
  ds_read_b64_tr_b16 v[48:49], v18 offset:96
  ds_read_b64_tr_b16 v[50:51], v19 offset:96
  ds_read_b64_tr_b16 v[52:53], v18 offset:128
  ds_read_b64_tr_b16 v[54:55], v19 offset:128
  ds_read_b64_tr_b16 v[56:57], v20 offset:0
  ds_read_b64_tr_b16 v[58:59], v21 offset:0
  ds_read_b128 v[40:43], v15 offset:0
  ds_read_b128 v[44:47], v15 offset:4096
  ds_read_b64_tr_b16 v[60:61], v18 offset:5216
  ds_read_b64_tr_b16 v[62:63], v19 offset:5216
  ds_read_b64_tr_b16 v[64:65], v18 offset:5248
  ds_read_b64_tr_b16 v[66:67], v19 offset:5248
  ds_read_b64_tr_b16 v[68:69], v20 offset:1024
  ds_read_b64_tr_b16 v[70:71], v21 offset:1024
  s_waitcnt lgkmcnt(8)
  v_mfma_f32_16x16x32_bf16 v[72:75], v[48:51], v[32:35], v[72:75]
  v_mfma_f32_16x16x32_bf16 v[76:79], v[48:51], v[36:39], v[76:79]
  v_mfma_f32_16x16x32_bf16 v[96:99], v[48:51], v[108:111], v[96:99]
  v_mfma_f32_16x16x32_bf16 v[80:83], v[52:55], v[32:35], v[80:83]
  v_mfma_f32_16x16x32_bf16 v[84:87], v[52:55], v[36:39], v[84:87]
  v_mfma_f32_16x16x32_bf16 v[100:103], v[52:55], v[108:111], v[100:103]
  v_mfma_f32_16x16x32_bf16 v[88:91], v[56:59], v[32:35], v[88:91]
  v_mfma_f32_16x16x32_bf16 v[92:95], v[56:59], v[36:39], v[92:95]
  v_mfma_f32_16x16x32_bf16 v[104:107], v[56:59], v[108:111], v[104:107]
  v_mfma_f32_16x16x32_bf16 v[136:139], v[108:111], v[36:39], v[136:139]
  v_mfma_f32_16x16x32_bf16 v[140:143], v[36:39], v[36:39], v[140:143]
  ds_read_b128 v[32:35], v16 offset:0
  ds_read_b128 v[36:39], v16 offset:4096
  ds_read_b64_tr_b16 v[48:49], v18 offset:10336
  ds_read_b64_tr_b16 v[50:51], v19 offset:10336
  ds_read_b64_tr_b16 v[52:53], v18 offset:10368
  ds_read_b64_tr_b16 v[54:55], v19 offset:10368
  ds_read_b64_tr_b16 v[56:57], v20 offset:2048
  ds_read_b64_tr_b16 v[58:59], v21 offset:2048
  s_waitcnt lgkmcnt(8)
  v_mfma_f32_16x16x32_bf16 v[72:75], v[60:63], v[40:43], v[72:75]
  v_mfma_f32_16x16x32_bf16 v[76:79], v[60:63], v[44:47], v[76:79]
  v_mfma_f32_16x16x32_bf16 v[96:99], v[60:63], v[108:111], v[96:99]
  v_mfma_f32_16x16x32_bf16 v[80:83], v[64:67], v[40:43], v[80:83]
  v_mfma_f32_16x16x32_bf16 v[84:87], v[64:67], v[44:47], v[84:87]
  v_mfma_f32_16x16x32_bf16 v[100:103], v[64:67], v[108:111], v[100:103]
  v_mfma_f32_16x16x32_bf16 v[88:91], v[68:71], v[40:43], v[88:91]
  v_mfma_f32_16x16x32_bf16 v[92:95], v[68:71], v[44:47], v[92:95]
  v_mfma_f32_16x16x32_bf16 v[104:107], v[68:71], v[108:111], v[104:107]
  v_mfma_f32_16x16x32_bf16 v[136:139], v[108:111], v[44:47], v[136:139]
  v_mfma_f32_16x16x32_bf16 v[140:143], v[44:47], v[44:47], v[140:143]
  ds_read_b128 v[40:43], v17 offset:0
  ds_read_b128 v[44:47], v17 offset:4096
  ds_read_b64_tr_b16 v[60:61], v18 offset:15456
  ds_read_b64_tr_b16 v[62:63], v19 offset:15456
  ds_read_b64_tr_b16 v[64:65], v18 offset:15488
  ds_read_b64_tr_b16 v[66:67], v19 offset:15488
  ds_read_b64_tr_b16 v[68:69], v20 offset:3072
  ds_read_b64_tr_b16 v[70:71], v21 offset:3072
  s_waitcnt lgkmcnt(8)
  v_mfma_f32_16x16x32_bf16 v[72:75], v[48:51], v[32:35], v[72:75]
  v_mfma_f32_16x16x32_bf16 v[76:79], v[48:51], v[36:39], v[76:79]
  v_mfma_f32_16x16x32_bf16 v[96:99], v[48:51], v[108:111], v[96:99]
  v_mfma_f32_16x16x32_bf16 v[80:83], v[52:55], v[32:35], v[80:83]
  v_mfma_f32_16x16x32_bf16 v[84:87], v[52:55], v[36:39], v[84:87]
  v_mfma_f32_16x16x32_bf16 v[100:103], v[52:55], v[108:111], v[100:103]
  v_mfma_f32_16x16x32_bf16 v[88:91], v[56:59], v[32:35], v[88:91]
  v_mfma_f32_16x16x32_bf16 v[92:95], v[56:59], v[36:39], v[92:95]
  v_mfma_f32_16x16x32_bf16 v[104:107], v[56:59], v[108:111], v[104:107]
  v_mfma_f32_16x16x32_bf16 v[136:139], v[108:111], v[36:39], v[136:139]
  v_mfma_f32_16x16x32_bf16 v[140:143], v[36:39], v[36:39], v[140:143]
  s_waitcnt lgkmcnt(0)
  v_mfma_f32_16x16x32_bf16 v[72:75], v[60:63], v[40:43], v[72:75]
  v_mfma_f32_16x16x32_bf16 v[76:79], v[60:63], v[44:47], v[76:79]
  v_mfma_f32_16x16x32_bf16 v[96:99], v[60:63], v[108:111], v[96:99]
  v_mfma_f32_16x16x32_bf16 v[80:83], v[64:67], v[40:43], v[80:83]
  v_mfma_f32_16x16x32_bf16 v[84:87], v[64:67], v[44:47], v[84:87]
  v_mfma_f32_16x16x32_bf16 v[100:103], v[64:67], v[108:111], v[100:103]
  v_mfma_f32_16x16x32_bf16 v[88:91], v[68:71], v[40:43], v[88:91]
  v_mfma_f32_16x16x32_bf16 v[92:95], v[68:71], v[44:47], v[92:95]
  v_mfma_f32_16x16x32_bf16 v[104:107], v[68:71], v[108:111], v[104:107]
  v_mfma_f32_16x16x32_bf16 v[136:139], v[108:111], v[44:47], v[136:139]
  v_mfma_f32_16x16x32_bf16 v[140:143], v[44:47], v[44:47], v[140:143]
  s_add_u32 s56, s56, 1
  s_and_b32 s33, s56, 3
  s_cmp_eq_u32 s33, 0
  s_cselect_b32 s57, -122880, s59
  s_cmp_lt_u32 s56, 5
  s_cbranch_scc1 L_k1_qkv_kernel_5
  s_waitcnt vmcnt(0)
  s_nop 7
  s_nop 7
  v_and_b32 v22, 3, v3
  v_cmp_eq_u32 vcc, 1, v22
  v_cndmask_b32 v113, v140, v141, vcc
  v_cmp_eq_u32 vcc, 2, v22
  v_cndmask_b32 v113, v113, v142, vcc
  v_cmp_eq_u32 vcc, 3, v22
  v_cndmask_b32 v113, v113, v143, vcc
  v_lshrrev_b32 v22, 2, v3
  v_cmp_eq_u32 vcc, v22, v2
  v_cndmask_b32 v113, 0, v113, vcc
  v_cmp_eq_u32 vcc, 0, v2
  v_cndmask_b32 v112, 0, v136, vcc
  v_mov_b32 v22, v112
  v_mov_b32 v23, v112
  s_nop 1
  v_permlane16_swap_b32 v22, v23
  s_nop 1
  v_add_f32 v112, v22, v23
  v_mov_b32 v22, v112
  v_mov_b32 v23, v112
  s_nop 1
  v_permlane32_swap_b32 v22, v23
  s_nop 1
  v_add_f32 v112, v22, v23
  v_mov_b32 v22, v113
  v_mov_b32 v23, v113
  s_nop 1
  v_permlane16_swap_b32 v22, v23
  s_nop 1
  v_add_f32 v113, v22, v23
  v_mov_b32 v22, v113
  v_mov_b32 v23, v113
  s_nop 1
  v_permlane32_swap_b32 v22, v23
  s_nop 1
  v_add_f32 v113, v22, v23
  v_mul_f32 v24, 0x3acccccd, v112
  v_mul_f32 v22, 0x3acccccd, v113
  v_fma_f32 v22, -v24, v24, v22
  v_max_f32 v22, 0, v22
  v_add_f32 v22, 0x3727c5ac, v22
  v_rsq_f32 v25, v22
  s_nop 0
  s_and_b32 s33, s24, 1
  s_lshl_b32 s33, s33, 8
  v_lshlrev_b32 v26, 3, v3
  v_add_u32 v26, s33, v26
  s_barrier
  ds_write_b64 v26, v[24:25] offset:128
  s_waitcnt lgkmcnt(0)
  s_barrier
  ds_read_b64 v[28:29], v26
  ds_read_b64 v[30:31], v26 offset:128
  s_waitcnt lgkmcnt(0)
  v_mul_f32 v129, 0x3ea52b5c, v29
  v_mul_f32 v130, 0x3ea52b5c, v31
  v_fma_f32 v72, -v28, v96, v72
  v_mul_f32 v72, v72, v129
  v_fma_f32 v73, -v28, v97, v73
  v_mul_f32 v73, v73, v129
  v_fma_f32 v74, -v28, v98, v74
  v_mul_f32 v74, v74, v129
  v_fma_f32 v75, -v28, v99, v75
  v_mul_f32 v75, v75, v129
  v_fma_f32 v76, -v30, v96, v76
  v_mul_f32 v76, v76, v130
  v_fma_f32 v77, -v30, v97, v77
  v_mul_f32 v77, v77, v130
  v_fma_f32 v78, -v30, v98, v78
  v_mul_f32 v78, v78, v130
  v_fma_f32 v79, -v30, v99, v79
  v_mul_f32 v79, v79, v130
  v_cvt_pk_bf16_f32 v72, v72, v73
  v_cvt_pk_bf16_f32 v73, v74, v75
  s_mov_b32 s33, 0
  buffer_store_dwordx2 v[72:73], v128, s[16:19], s33 offen offset:0
  v_cvt_pk_bf16_f32 v76, v76, v77
  v_cvt_pk_bf16_f32 v77, v78, v79
  s_mov_b32 s33, 20480
  buffer_store_dwordx2 v[76:77], v128, s[16:19], s33 offen offset:0
  v_fma_f32 v80, -v28, v100, v80
  v_mul_f32 v80, v80, v129
  v_fma_f32 v81, -v28, v101, v81
  v_mul_f32 v81, v81, v129
  v_fma_f32 v82, -v28, v102, v82
  v_mul_f32 v82, v82, v129
  v_fma_f32 v83, -v28, v103, v83
  v_mul_f32 v83, v83, v129
  v_fma_f32 v84, -v30, v100, v84
  v_mul_f32 v84, v84, v130
  v_fma_f32 v85, -v30, v101, v85
  v_mul_f32 v85, v85, v130
  v_fma_f32 v86, -v30, v102, v86
  v_mul_f32 v86, v86, v130
  v_fma_f32 v87, -v30, v103, v87
  v_mul_f32 v87, v87, v130
  v_cvt_pk_bf16_f32 v80, v80, v81
  v_cvt_pk_bf16_f32 v81, v82, v83
  s_mov_b32 s33, 0
  buffer_store_dwordx2 v[80:81], v128, s[16:19], s33 offen offset:32
  v_cvt_pk_bf16_f32 v84, v84, v85
  v_cvt_pk_bf16_f32 v85, v86, v87
  s_mov_b32 s33, 20480
  buffer_store_dwordx2 v[84:85], v128, s[16:19], s33 offen offset:32
  v_fma_f32 v88, -v28, v104, v88
  v_mul_f32 v88, v88, v29
  v_fma_f32 v89, -v28, v105, v89
  v_mul_f32 v89, v89, v29
  v_fma_f32 v90, -v28, v106, v90
  v_mul_f32 v90, v90, v29
  v_fma_f32 v91, -v28, v107, v91
  v_mul_f32 v91, v91, v29
  v_fma_f32 v92, -v30, v104, v92
  v_mul_f32 v92, v92, v31
  v_fma_f32 v93, -v30, v105, v93
  v_mul_f32 v93, v93, v31
  v_fma_f32 v94, -v30, v106, v94
  v_mul_f32 v94, v94, v31
  v_fma_f32 v95, -v30, v107, v95
  v_mul_f32 v95, v95, v31
  s_cmp_ge_u32 s26, 4
  s_cbranch_scc1 L_k1_qkv_kernel_8
  s_lshl_b32 s33, s25, 1
  s_and_b32 s34, s24, 1
  s_add_u32 s33, s33, s34
  s_lshl_b32 s35, s33, 12
  s_bitcmp1_b32 s26, 1
  s_cbranch_scc1 L_k1_qkv_kernel_7
  s_and_b32 s34, s26, 1
  s_lshl_b32 s36, s34, 10
  s_add_u32 s35, s35, s36
  v_lshrrev_b32 v22, 1, v2
  v_lshlrev_b32 v22, 9, v22
  v_lshl_add_u32 v22, v3, 4, v22
  v_and_b32 v23, 1, v2
  v_lshl_add_u32 v22, v23, 3, v22
  v_add_u32 v22, s35, v22
  v_cmp_eq_u32 vcc, 0, v2
  v_cmp_eq_u32 s[52:53], 1, v2
  s_cmp_eq_u32 s34, 0
  s_cselect_b64 vcc, -1, vcc
  s_cselect_b64 s[52:53], 0, s[52:53]
  v_mov_b32 v24, 0
  v_cvt_pk_bf16_f32 v88, v88, v89
  v_cvt_pk_bf16_f32 v89, v90, v91
  v_cndmask_b32 v88, 0, v88, vcc
  v_cndmask_b32 v89, 0, v89, vcc
  v_dot2_f32_bf16 v90, v88, v88, v24
  v_dot2_f32_bf16 v90, v89, v89, v90
  v_mov_b32 v25, 0x3f803f80
  v_mov_b32 v26, 0x00003f80
  v_cndmask_b32 v88, v88, v25, s[52:53]
  v_cndmask_b32 v89, v89, v26, s[52:53]
  buffer_store_dwordx2 v[88:89], v22, s[20:23], 0 offen offset:0
  v_mov_b32 v27, v90
  v_mov_b32 v28, v90
  s_nop 1
  v_permlane16_swap_b32 v27, v28
  s_nop 1
  v_add_f32 v90, v27, v28
  v_mov_b32 v27, v90
  v_mov_b32 v28, v90
  s_nop 1
  v_permlane32_swap_b32 v27, v28
  s_nop 1
  v_add_f32 v90, v27, v28
  v_cvt_pk_bf16_f32 v92, v92, v93
  v_cvt_pk_bf16_f32 v93, v94, v95
  v_cndmask_b32 v92, 0, v92, vcc
  v_cndmask_b32 v93, 0, v93, vcc
  v_dot2_f32_bf16 v94, v92, v92, v24
  v_dot2_f32_bf16 v94, v93, v93, v94
  v_mov_b32 v25, 0x3f803f80
  v_mov_b32 v26, 0x00003f80
  v_cndmask_b32 v92, v92, v25, s[52:53]
  v_cndmask_b32 v93, v93, v26, s[52:53]
  buffer_store_dwordx2 v[92:93], v22, s[20:23], 0 offen offset:256
  v_mov_b32 v27, v94
  v_mov_b32 v28, v94
  s_nop 1
  v_permlane16_swap_b32 v27, v28
  s_nop 1
  v_add_f32 v94, v27, v28
  v_mov_b32 v27, v94
  v_mov_b32 v28, v94
  s_nop 1
  v_permlane32_swap_b32 v27, v28
  s_nop 1
  v_add_f32 v94, v27, v28
  v_max_f32 v90, v90, v94
  s_nop 1
  v_max_f32_dpp v90, v90, v90 row_ror:8 row_mask:0xf bank_mask:0xf
  s_nop 1
  v_max_f32_dpp v90, v90, v90 row_ror:4 row_mask:0xf bank_mask:0xf
  s_nop 1
  v_max_f32_dpp v90, v90, v90 row_ror:2 row_mask:0xf bank_mask:0xf
  s_nop 1
  v_max_f32_dpp v90, v90, v90 row_ror:1 row_mask:0xf bank_mask:0xf
  s_lshl_b32 s34, s34, 6
  s_add_u32 s33, s33, s34
  s_lshl_b32 s33, s33, 2
  s_add_u32 s33, s33, 0x40000
  v_mov_b32 v22, s33
  v_cmp_eq_u32 vcc, 0, v1
  s_and_saveexec_b64 s[52:53], vcc
  buffer_store_dword v90, v22, s[20:23], 0 offen
  s_mov_b64 exec, s[52:53]
  s_branch L_k1_qkv_kernel_8
L_k1_qkv_kernel_7:
  s_and_b32 s34, s26, 1
  s_lshl_b32 s36, s34, 8
  s_add_u32 s35, s35, s36
  s_add_u32 s35, s35, 2048
  v_lshlrev_b32 v22, 6, v2
  v_bfe_u32 v23, v3, 2, 1
  v_lshl_add_u32 v22, v23, 9, v22
  v_and_b32 v23, 3, v3
  v_lshl_add_u32 v22, v23, 1, v22
  v_lshrrev_b32 v23, 3, v3
  v_lshl_add_u32 v22, v23, 3, v22
  v_add_u32 v22, s35, v22
  v_cmp_eq_u32 vcc, 0, v2
  v_cmp_eq_u32 s[52:53], 1, v2
  s_cmp_eq_u32 s34, 0
  s_cselect_b64 vcc, -1, vcc
  s_cselect_b64 s[52:53], 0, s[52:53]
  v_mov_b32 v25, 0x3f80
  v_cvt_pk_bf16_f32 v88, v88, v89
  v_cvt_pk_bf16_f32 v89, v90, v91
  v_cndmask_b32 v88, 0, v88, vcc
  v_cndmask_b32 v89, 0, v89, vcc
  v_cndmask_b32 v88, v88, v25, s[52:53]
  buffer_store_short v88, v22, s[20:23], 0 offen offset:0
  buffer_store_short_d16_hi v88, v22, s[20:23], 0 offen offset:16
  buffer_store_short v89, v22, s[20:23], 0 offen offset:32
  buffer_store_short_d16_hi v89, v22, s[20:23], 0 offen offset:48
  v_cvt_pk_bf16_f32 v92, v92, v93
  v_cvt_pk_bf16_f32 v93, v94, v95
  v_cndmask_b32 v92, 0, v92, vcc
  v_cndmask_b32 v93, 0, v93, vcc
  v_cndmask_b32 v92, v92, v25, s[52:53]
  buffer_store_short v92, v22, s[20:23], 0 offen offset:1024
  buffer_store_short_d16_hi v92, v22, s[20:23], 0 offen offset:1040
  buffer_store_short v93, v22, s[20:23], 0 offen offset:1056
  buffer_store_short_d16_hi v93, v22, s[20:23], 0 offen offset:1072
L_k1_qkv_kernel_8:
  s_endpgm
L_k1_qkv_kernel_1:
  s_lshl_b32 s33, s25, 6
  s_mul_i32 s33, s33, 1280
  v_add_u32 v22, 0, v2
  v_xor_b32 v23, v22, v3
  v_lshlrev_b32 v23, 4, v23
  v_mul_u32_u24 v22, 1280, v22
  v_add3_u32 v4, v22, v23, s33
  v_add_u32 v22, 4, v2
  v_xor_b32 v23, v22, v3
  v_lshlrev_b32 v23, 4, v23
  v_mul_u32_u24 v22, 1280, v22
  v_add3_u32 v5, v22, v23, s33
  v_add_u32 v22, 8, v2
  v_xor_b32 v23, v22, v3
  v_lshlrev_b32 v23, 4, v23
  v_mul_u32_u24 v22, 1280, v22
  v_add3_u32 v6, v22, v23, s33
  v_add_u32 v22, 12, v2
  v_xor_b32 v23, v22, v3
  v_lshlrev_b32 v23, 4, v23
  v_mul_u32_u24 v22, 1280, v22
  v_add3_u32 v7, v22, v23, s33
  v_lshrrev_b32 v22, 1, v1
  v_lshrrev_b32 v23, 1, v22
  v_and_b32 v23, 4, v23
  v_xor_b32 v22, v22, v23
  v_mul_u32_u24 v22, 40, v22
  v_and_b32 v23, 1, v1
  v_lshlrev_b32 v23, 4, v23
  s_and_b32 s33, s26, 1
  s_lshl_b32 s33, s33, 5
  v_add3_u32 v13, v22, v23, s33
  s_waitcnt lgkmcnt(0)
  s_mov_b32 s4, s40
  s_mov_b32 s5, s41
  s_mov_b32 s6, 0x280000
  s_mov_b32 s7, 0x20000
  s_mov_b32 s8, s42
  s_mov_b32 s9, s43
  s_mov_b32 s10, 0xc8000
  s_mov_b32 s11, 0x20000
  s_bitcmp1_b32 s26, 1
  s_cselect_b32 s12, s48, s46
  s_cselect_b32 s13, s49, s47
  s_cmp_lt_u32 s26, 4
  s_cselect_b32 s14, 25600, 0
  s_mov_b32 s15, 0x20000
  s_mov_b32 s16, s44
  s_mov_b32 s17, s45
  s_mov_b32 s18, 0x280000
  s_mov_b32 s19, 0x20000
  s_add_u32 s20, s44, 0x280000
  s_addc_u32 s21, s45, 0
  s_mov_b32 s22, 0x40200
  s_mov_b32 s23, 0x20000
  s_setprio 3
  s_mov_b32 s27, 0
  s_mov_b32 s28, 0
  s_mov_b32 s29, 0
  s_mov_b32 s55, 0
  s_mov_b32 s56, 0
L_k1_qkv_kernel_9:
  s_cmp_lt_u32 s56, 3
  s_cbranch_scc1 L_k1_qkv_kernel_10
  s_waitcnt vmcnt(40)
  s_barrier
L_k1_qkv_kernel_10:
  s_add_u32 m0, s55, 0
  s_add_u32 s33, s27, 0
  buffer_load_dwordx4 v4, s[4:7], s33 offen lds
  s_add_u32 m0, s55, 1024
  s_add_u32 s33, s27, 0
  buffer_load_dwordx4 v5, s[4:7], s33 offen lds
  s_add_u32 m0, s55, 2048
  s_add_u32 s33, s27, 0
  buffer_load_dwordx4 v6, s[4:7], s33 offen lds
  s_add_u32 m0, s55, 3072
  s_add_u32 s33, s27, 0
  buffer_load_dwordx4 v7, s[4:7], s33 offen lds
  s_add_u32 m0, s55, 4096
  s_add_u32 s33, s27, 20480
  buffer_load_dwordx4 v4, s[4:7], s33 offen lds
  s_add_u32 m0, s55, 5120
  s_add_u32 s33, s27, 20480
  buffer_load_dwordx4 v5, s[4:7], s33 offen lds
  s_add_u32 m0, s55, 6144
  s_add_u32 s33, s27, 20480
  buffer_load_dwordx4 v6, s[4:7], s33 offen lds
  s_add_u32 m0, s55, 7168
  s_add_u32 s33, s27, 20480
  buffer_load_dwordx4 v7, s[4:7], s33 offen lds
  s_add_u32 m0, s55, 8192
  s_add_u32 s33, s27, 40960
  buffer_load_dwordx4 v4, s[4:7], s33 offen lds
  s_add_u32 m0, s55, 9216
  s_add_u32 s33, s27, 40960
  buffer_load_dwordx4 v5, s[4:7], s33 offen lds
  s_add_u32 m0, s55, 10240
  s_add_u32 s33, s27, 40960
  buffer_load_dwordx4 v6, s[4:7], s33 offen lds
  s_add_u32 m0, s55, 11264
  s_add_u32 s33, s27, 40960
  buffer_load_dwordx4 v7, s[4:7], s33 offen lds
  s_add_u32 m0, s55, 12288
  s_add_u32 s33, s27, 61440
  buffer_load_dwordx4 v4, s[4:7], s33 offen lds
  s_add_u32 m0, s55, 13312
  s_add_u32 s33, s27, 61440
  buffer_load_dwordx4 v5, s[4:7], s33 offen lds
  s_add_u32 m0, s55, 14336
  s_add_u32 s33, s27, 61440
  buffer_load_dwordx4 v6, s[4:7], s33 offen lds
  s_add_u32 m0, s55, 15360
  s_add_u32 s33, s27, 61440
  buffer_load_dwordx4 v7, s[4:7], s33 offen lds
  s_add_u32 m0, s55, 36864
  s_add_u32 s33, s29, 0
  buffer_load_dwordx4 v13, s[12:15], s33 offen lds
  s_add_u32 m0, s55, 37888
  s_add_u32 s33, s29, 1280
  buffer_load_dwordx4 v13, s[12:15], s33 offen lds
  s_add_u32 m0, s55, 38912
  s_add_u32 s33, s29, 2560
  buffer_load_dwordx4 v13, s[12:15], s33 offen lds
  s_add_u32 m0, s55, 39936
  s_add_u32 s33, s29, 3840
  buffer_load_dwordx4 v13, s[12:15], s33 offen lds
  s_add_u32 s27, s27, 256
  s_add_u32 s29, s29, 5120
  s_add_u32 s55, s55, 40960
  s_cmp_eq_u32 s55, 163840
  s_cselect_b32 s55, 0, s55
  s_add_u32 s56, s56, 1
  s_cmp_lt_u32 s56, 5
  s_cbranch_scc1 L_k1_qkv_kernel_9
  s_waitcnt vmcnt(40)
  s_barrier
  s_waitcnt vmcnt(20)
  s_barrier
  s_waitcnt vmcnt(0)
  s_barrier
  s_endpgm
L_k1_qkv_kernel_2:
  s_mul_i32 s33, s26, 160
  s_movk_i32 s34, 6554
  v_add_u32 v22, 0, v1
  v_mul_u32_u24 v23, s34, v22
  v_lshrrev_b32 v23, 16, v23
  v_mul_u32_u24 v24, 10, v23
  v_sub_u32 v24, v22, v24
  v_lshrrev_b32 v25, 1, v23
  v_and_b32 v25, 4, v25
  v_xor_b32 v23, v23, v25
  v_mul_u32_u24 v23, 1280, v23
  v_lshlrev_b32 v24, 4, v24
  v_add3_u32 v8, v23, v24, s33
  v_add_u32 v22, 64, v1
  v_mul_u32_u24 v23, s34, v22
  v_lshrrev_b32 v23, 16, v23
  v_mul_u32_u24 v24, 10, v23
  v_sub_u32 v24, v22, v24
  v_lshrrev_b32 v25, 1, v23
  v_and_b32 v25, 4, v25
  v_xor_b32 v23, v23, v25
  v_mul_u32_u24 v23, 1280, v23
  v_lshlrev_b32 v24, 4, v24
  v_add3_u32 v9, v23, v24, s33
  v_add_u32 v22, 128, v1
  v_mul_u32_u24 v23, s34, v22
  v_lshrrev_b32 v23, 16, v23
  v_mul_u32_u24 v24, 10, v23
  v_sub_u32 v24, v22, v24
  v_lshrrev_b32 v25, 1, v23
  v_and_b32 v25, 4, v25
  v_xor_b32 v23, v23, v25
  v_mul_u32_u24 v23, 1280, v23
  v_lshlrev_b32 v24, 4, v24
  v_add3_u32 v10, v23, v24, s33
  v_add_u32 v22, 192, v1
  v_mul_u32_u24 v23, s34, v22
  v_lshrrev_b32 v23, 16, v23
  v_mul_u32_u24 v24, 10, v23
  v_sub_u32 v24, v22, v24
  v_lshrrev_b32 v25, 1, v23
  v_and_b32 v25, 4, v25
  v_xor_b32 v23, v23, v25
  v_mul_u32_u24 v23, 1280, v23
  v_lshlrev_b32 v24, 4, v24
  v_add3_u32 v11, v23, v24, s33
  v_add_u32 v22, 256, v1
  v_mul_u32_u24 v23, s34, v22
  v_lshrrev_b32 v23, 16, v23
  v_mul_u32_u24 v24, 10, v23
  v_sub_u32 v24, v22, v24
  v_lshrrev_b32 v25, 1, v23
  v_and_b32 v25, 4, v25
  v_xor_b32 v23, v23, v25
  v_mul_u32_u24 v23, 1280, v23
  v_lshlrev_b32 v24, 4, v24
  v_add3_u32 v12, v23, v24, s33
  s_waitcnt lgkmcnt(0)
  s_mov_b32 s4, s40
  s_mov_b32 s5, s41
  s_mov_b32 s6, 0x280000
  s_mov_b32 s7, 0x20000
  s_mov_b32 s8, s42
  s_mov_b32 s9, s43
  s_mov_b32 s10, 0xc8000
  s_mov_b32 s11, 0x20000
  s_bitcmp1_b32 s26, 1
  s_cselect_b32 s12, s48, s46
  s_cselect_b32 s13, s49, s47
  s_cmp_lt_u32 s26, 4
  s_cselect_b32 s14, 25600, 0
  s_mov_b32 s15, 0x20000
  s_mov_b32 s16, s44
  s_mov_b32 s17, s45
  s_mov_b32 s18, 0x280000
  s_mov_b32 s19, 0x20000
  s_add_u32 s20, s44, 0x280000
  s_addc_u32 s21, s45, 0
  s_mov_b32 s22, 0x40200
  s_mov_b32 s23, 0x20000
  s_setprio 3
  s_mov_b32 s27, 0
  s_mov_b32 s28, 0
  s_mov_b32 s29, 0
  s_mov_b32 s55, 0
  s_mov_b32 s56, 0
L_k1_qkv_kernel_12:
  s_cmp_lt_u32 s56, 3
  s_cbranch_scc1 L_k1_qkv_kernel_13
  s_waitcnt vmcnt(40)
  s_barrier
L_k1_qkv_kernel_13:
  s_add_u32 m0, s55, 16384
  s_add_u32 s33, s28, 0
  buffer_load_dwordx4 v8, s[8:11], s33 offen lds
  s_add_u32 m0, s55, 17408
  s_add_u32 s33, s28, 0
  buffer_load_dwordx4 v9, s[8:11], s33 offen lds
  s_add_u32 m0, s55, 18432
  s_add_u32 s33, s28, 0
  buffer_load_dwordx4 v10, s[8:11], s33 offen lds
  s_add_u32 m0, s55, 19456
  s_add_u32 s33, s28, 0
  buffer_load_dwordx4 v11, s[8:11], s33 offen lds
  s_add_u32 m0, s55, 20480
  s_add_u32 s33, s28, 0
  buffer_load_dwordx4 v12, s[8:11], s33 offen lds
  s_add_u32 m0, s55, 21504
  s_add_u32 s33, s28, 40960
  buffer_load_dwordx4 v8, s[8:11], s33 offen lds
  s_add_u32 m0, s55, 22528
  s_add_u32 s33, s28, 40960
  buffer_load_dwordx4 v9, s[8:11], s33 offen lds
  s_add_u32 m0, s55, 23552
  s_add_u32 s33, s28, 40960
  buffer_load_dwordx4 v10, s[8:11], s33 offen lds
  s_add_u32 m0, s55, 24576
  s_add_u32 s33, s28, 40960
  buffer_load_dwordx4 v11, s[8:11], s33 offen lds
  s_add_u32 m0, s55, 25600
  s_add_u32 s33, s28, 40960
  buffer_load_dwordx4 v12, s[8:11], s33 offen lds
  s_add_u32 m0, s55, 26624
  s_add_u32 s33, s28, 81920
  buffer_load_dwordx4 v8, s[8:11], s33 offen lds
  s_add_u32 m0, s55, 27648
  s_add_u32 s33, s28, 81920
  buffer_load_dwordx4 v9, s[8:11], s33 offen lds
  s_add_u32 m0, s55, 28672
  s_add_u32 s33, s28, 81920
  buffer_load_dwordx4 v10, s[8:11], s33 offen lds
  s_add_u32 m0, s55, 29696
  s_add_u32 s33, s28, 81920
  buffer_load_dwordx4 v11, s[8:11], s33 offen lds
  s_add_u32 m0, s55, 30720
  s_add_u32 s33, s28, 81920
  buffer_load_dwordx4 v12, s[8:11], s33 offen lds
  s_add_u32 m0, s55, 31744
  s_add_u32 s33, s28, 122880
  buffer_load_dwordx4 v8, s[8:11], s33 offen lds
  s_add_u32 m0, s55, 32768
  s_add_u32 s33, s28, 122880
  buffer_load_dwordx4 v9, s[8:11], s33 offen lds
  s_add_u32 m0, s55, 33792
  s_add_u32 s33, s28, 122880
  buffer_load_dwordx4 v10, s[8:11], s33 offen lds
  s_add_u32 m0, s55, 34816
  s_add_u32 s33, s28, 122880
  buffer_load_dwordx4 v11, s[8:11], s33 offen lds
  s_add_u32 m0, s55, 35840
  s_add_u32 s33, s28, 122880
  buffer_load_dwordx4 v12, s[8:11], s33 offen lds
  s_add_u32 s28, s28, 163840
  s_add_u32 s55, s55, 40960
  s_cmp_eq_u32 s55, 163840
  s_cselect_b32 s55, 0, s55
  s_add_u32 s56, s56, 1
  s_cmp_lt_u32 s56, 5
  s_cbranch_scc1 L_k1_qkv_kernel_12
  s_waitcnt vmcnt(40)
  s_barrier
  s_waitcnt vmcnt(20)
  s_barrier
  s_waitcnt vmcnt(0)
  s_barrier
  s_endpgm
L_k1_qkv_kernel_end:
  s_endpgm
.globl k2_attn_kernel
.p2align 8
.type k2_attn_kernel,@function
k2_attn_kernel:
  s_cmp_ge_u32 s2, 366
  s_cbranch_scc1 L_k2_attn_kernel_end
  s_load_dwordx2 s[40:41], s[0:1], 88
  s_load_dwordx2 s[42:43], s[0:1], 48
  s_load_dwordx2 s[44:45], s[0:1], 56
  v_and_b32 v1, 63, v0
  v_lshrrev_b32 v96, 6, v0
  v_lshrrev_b32 v2, 5, v1
  v_readfirstlane_b32 s24, v96
  s_cmp_ge_u32 s2, 256
  s_cbranch_scc1 Lcs_k2_attn_kernel_1
  s_setprio 3
  s_waitcnt lgkmcnt(0)
  s_mov_b32 s4, s40
  s_mov_b32 s5, s41
  s_mov_b32 s6, 0x280000
  s_mov_b32 s7, 0x20000
  s_add_u32 s8, s40, 0x280000
  s_addc_u32 s9, s41, 0
  s_mov_b32 s10, 0x40000
  s_mov_b32 s11, 0x20000
  s_add_u32 s12, s40, 0x300000
  s_addc_u32 s13, s41, 0
  s_mov_b32 s14, 0x280000
  s_mov_b32 s15, 0x20000
  s_add_u32 s16, s40, 0x2c0000
  s_addc_u32 s17, s41, 0
  s_mov_b32 s18, 0x200
  s_mov_b32 s19, 0x20000
  s_and_b32 s33, s2, 7
  s_lshl_b32 s33, s33, 5
  s_lshr_b32 s34, s2, 3
  s_add_u32 s33, s33, s34
  s_lshl_b32 s33, s33, 3
  s_add_u32 s33, s33, s24
  s_mul_i32 s33, s33, 1280
  v_and_b32 v96, 31, v1
  v_mul_u32_u24 v96, 40, v96
  v_add_u32 v15, s33, v96
  v_lshl_add_u32 v97, v2, 4, v15
  buffer_load_dwordx4 v[4:7], v97, s[4:7], 0 offen
  v_lshl_add_u32 v98, v2, 30, v15
  buffer_load_dwordx2 v[8:9], v98, s[4:7], 0 offen offset:32
  v_lshlrev_b32 v99, 2, v1
  buffer_load_dword v100, v99, s[16:19], 0 offen
  buffer_load_dword v101, v99, s[16:19], 0 offen offset:256
  v_lshlrev_b32 v12, 4, v1
  s_lshl_b32 s27, s24, 11
  v_add_u32 v14, s27, v12
  v_add_u32 v13, 16384, v12
  s_mov_b32 s26, 0
  s_add_u32 m0, s27, 0
  s_nop 0
  buffer_load_dwordx4 v14, s[8:11], s26 offen lds
  s_add_u32 m0, s27, 0
  s_nop 0
  buffer_load_dwordx4 v14, s[8:11], s26 offen offset:1024 lds
  s_mov_b32 s26, 16384
  s_add_u32 m0, s27, 16384
  s_nop 0
  buffer_load_dwordx4 v14, s[8:11], s26 offen lds
  s_add_u32 m0, s27, 16384
  s_nop 0
  buffer_load_dwordx4 v14, s[8:11], s26 offen offset:1024 lds
  s_mov_b32 s26, 32768
  s_add_u32 m0, s27, 32768
  s_nop 0
  buffer_load_dwordx4 v14, s[8:11], s26 offen lds
  s_add_u32 m0, s27, 32768
  s_nop 0
  buffer_load_dwordx4 v14, s[8:11], s26 offen offset:1024 lds
  v_mov_b32 v64, 0
  v_mov_b32 v65, 0
  v_mov_b32 v66, 0
  v_mov_b32 v67, 0
  v_mov_b32 v68, 0
  v_mov_b32 v69, 0
  v_mov_b32 v70, 0
  v_mov_b32 v71, 0
  v_mov_b32 v72, 0
  v_mov_b32 v73, 0
  v_mov_b32 v74, 0
  v_mov_b32 v75, 0
  v_mov_b32 v76, 0
  v_mov_b32 v77, 0
  v_mov_b32 v78, 0
  v_mov_b32 v79, 0
  v_mov_b32 v10, 0
  v_mov_b32 v11, 0
  s_waitcnt vmcnt(6)
  s_nop 1
  v_max_f32_dpp v100, v100, v100 row_ror:8 row_mask:0xf bank_mask:0xf
  s_nop 1
  v_max_f32_dpp v100, v100, v100 row_ror:4 row_mask:0xf bank_mask:0xf
  s_nop 1
  v_max_f32_dpp v100, v100, v100 row_ror:2 row_mask:0xf bank_mask:0xf
  s_nop 1
  v_max_f32_dpp v100, v100, v100 row_ror:1 row_mask:0xf bank_mask:0xf
  v_mov_b32 v102, v100
  v_mov_b32 v103, v100
  s_nop 1
  v_permlane16_swap_b32 v102, v103
  s_nop 1
  v_max_f32 v100, v102, v103
  v_mov_b32 v102, v100
  v_mov_b32 v103, v100
  s_nop 1
  v_permlane32_swap_b32 v102, v103
  s_nop 1
  v_max_f32 v100, v102, v103
  s_nop 1
  v_max_f32_dpp v101, v101, v101 row_ror:8 row_mask:0xf bank_mask:0xf
  s_nop 1
  v_max_f32_dpp v101, v101, v101 row_ror:4 row_mask:0xf bank_mask:0xf
  s_nop 1
  v_max_f32_dpp v101, v101, v101 row_ror:2 row_mask:0xf bank_mask:0xf
  s_nop 1
  v_max_f32_dpp v101, v101, v101 row_ror:1 row_mask:0xf bank_mask:0xf
  v_mov_b32 v102, v101
  v_mov_b32 v103, v101
  s_nop 1
  v_permlane16_swap_b32 v102, v103
  s_nop 1
  v_max_f32 v101, v102, v103
  v_mov_b32 v102, v101
  v_mov_b32 v103, v101
  s_nop 1
  v_permlane32_swap_b32 v102, v103
  s_nop 1
  v_max_f32 v101, v102, v103
  v_add_f32 v100, v100, v101
  v_mov_b32 v101, 0
  v_dot2_f32_bf16 v101, v4, v4, v101
  v_dot2_f32_bf16 v101, v5, v5, v101
  v_dot2_f32_bf16 v101, v6, v6, v101
  v_dot2_f32_bf16 v101, v7, v7, v101
  v_dot2_f32_bf16 v101, v8, v8, v101
  v_dot2_f32_bf16 v101, v9, v9, v101
  s_nop 3
  v_mov_b32 v102, v101
  v_mov_b32 v103, v101
  s_nop 1
  v_permlane32_swap_b32 v102, v103
  s_nop 1
  v_add_f32 v101, v102, v103
  v_mul_f32 v101, v101, v100
  v_sqrt_f32 v101, v101
  s_nop 0
  v_mul_f32 v101, 0x3f8147ae, v101
  v_mov_b32 v102, 0x42200000
  v_cmp_nle_f32 vcc, v101, v102
  s_cbranch_vccz Lfast_k2_attn_kernel_2
  v_mov_b32 v101, 0xff800000
  s_mov_b32 s25, 0
Lmx_k2_attn_kernel_3:
  buffer_load_dwordx4 v[80:83], v12, s[8:11], s25 offen
  buffer_load_dwordx4 v[84:87], v12, s[8:11], s25 offen offset:1024
  s_waitcnt vmcnt(0)
  v_mfma_f32_32x32x16_bf16 v[16:31], v[80:83], v[4:7], 0
  v_mfma_f32_32x32x16_bf16 v[16:31], v[84:87], v[8:11], v[16:31]
  s_nop 15
  s_nop 3
  v_max3_f32 v101, v16, v17, v101
  v_max3_f32 v101, v18, v19, v101
  v_max3_f32 v101, v20, v21, v101
  v_max3_f32 v101, v22, v23, v101
  v_max3_f32 v101, v24, v25, v101
  v_max3_f32 v101, v26, v27, v101
  v_max3_f32 v101, v28, v29, v101
  v_max3_f32 v101, v30, v31, v101
  s_add_u32 s25, s25, 4096
  s_cmp_lt_u32 s25, 0x40000
  s_cbranch_scc1 Lmx_k2_attn_kernel_3
  v_mov_b32 v102, v101
  v_mov_b32 v103, v101
  s_nop 1
  v_permlane32_swap_b32 v102, v103
  s_nop 1
  v_max_f32 v101, v102, v103
Lfast_k2_attn_kernel_2:
  v_sub_f32 v101, 0, v101
  v_cvt_pk_bf16_f32 v102, v101, v101
  v_lshlrev_b32 v102, 16, v102
  v_sub_f32 v101, v101, v102
  v_cvt_pk_bf16_f32 v103, v101, v101
  v_lshlrev_b32 v103, 16, v103
  v_sub_f32 v101, v101, v103
  v_cvt_pk_bf16_f32 v102, v102, v103
  v_cvt_pk_bf16_f32 v103, v101, 0
  v_cmp_eq_u32 vcc, 0, v2
  s_nop 1
  v_cndmask_b32 v10, 0, v102, vcc
  v_cndmask_b32 v11, 0, v103, vcc
  s_waitcnt vmcnt(2)
  s_barrier
  ds_read_b128 v[80:83], v12
  ds_read_b128 v[84:87], v12 offset:1024
  s_waitcnt lgkmcnt(0)
  v_mfma_f32_32x32x16_bf16 v[16:31], v[80:83], v[4:7], 0
  v_mfma_f32_32x32x16_bf16 v[16:31], v[84:87], v[8:11], v[16:31]
  ds_read_b128 v[80:83], v12 offset:4096
  ds_read_b128 v[84:87], v12 offset:5120
  ds_read_b128 v[92:95], v12 offset:3072
  ds_read_b128 v[88:91], v12 offset:2048
  v_mov_b32 v52, 0
  v_mov_b32 v53, 0
  v_mov_b32 v54, 0
  v_mov_b32 v55, 0
  s_mov_b32 s25, 0
  s_mov_b32 s26, 49152
  s_nop 7
  .p2align 6
Lloop_k2_attn_kernel_4:
  s_and_b32 s33, s26, 0xffff
  s_add_u32 m0, s33, s27
  s_nop 0
  buffer_load_dwordx4 v14, s[8:11], s26 offen lds
  buffer_load_dwordx4 v14, s[8:11], s26 offen offset:1024 lds
  s_add_u32 s26, s26, 16384
  s_waitcnt lgkmcnt(2)
  v_mfma_f32_32x32x16_bf16 v[32:47], v[80:83], v[4:7], 0
  v_exp_f32 v16, v16
  v_exp_f32 v17, v17
  v_exp_f32 v18, v18
  v_exp_f32 v19, v19
  v_mfma_f32_32x32x16_bf16 v[32:47], v[84:87], v[8:11], v[32:47]
  ds_read_b128 v[80:83], v12 offset:8192
  ds_read_b128 v[84:87], v12 offset:9216
  v_exp_f32 v20, v20
  v_exp_f32 v21, v21
  v_exp_f32 v22, v22
  v_exp_f32 v23, v23
  s_waitcnt lgkmcnt(3)
  v_mfma_f32_32x32x16_bf16 v[64:79], v[92:95], v[52:55], v[64:79]
  ds_read_b128 v[92:95], v12 offset:3072
  v_cvt_pk_bf16_f32 v48, v16, v17
  v_cvt_pk_bf16_f32 v49, v18, v19
  v_cvt_pk_bf16_f32 v50, v20, v21
  v_cvt_pk_bf16_f32 v51, v22, v23
  v_exp_f32 v24, v24
  v_exp_f32 v25, v25
  v_exp_f32 v26, v26
  s_waitcnt lgkmcnt(3)
  v_mfma_f32_32x32x16_bf16 v[64:79], v[88:91], v[48:51], v[64:79]
  ds_read_b128 v[88:91], v12 offset:6144
  v_exp_f32 v27, v27
  v_exp_f32 v28, v28
  v_exp_f32 v29, v29
  v_exp_f32 v30, v30
  v_exp_f32 v31, v31
  v_cvt_pk_bf16_f32 v52, v24, v25
  v_cvt_pk_bf16_f32 v53, v26, v27
  v_cvt_pk_bf16_f32 v54, v28, v29
  v_cvt_pk_bf16_f32 v55, v30, v31
  s_waitcnt lgkmcnt(2)
  v_mfma_f32_32x32x16_bf16 v[16:31], v[80:83], v[4:7], 0
  v_exp_f32 v32, v32
  v_exp_f32 v33, v33
  v_exp_f32 v34, v34
  v_exp_f32 v35, v35
  v_mfma_f32_32x32x16_bf16 v[16:31], v[84:87], v[8:11], v[16:31]
  ds_read_b128 v[80:83], v12 offset:12288
  ds_read_b128 v[84:87], v12 offset:13312
  v_exp_f32 v36, v36
  v_exp_f32 v37, v37
  v_exp_f32 v38, v38
  v_exp_f32 v39, v39
  s_waitcnt lgkmcnt(3)
  v_mfma_f32_32x32x16_bf16 v[64:79], v[92:95], v[52:55], v[64:79]
  ds_read_b128 v[92:95], v12 offset:7168
  v_cvt_pk_bf16_f32 v48, v32, v33
  v_cvt_pk_bf16_f32 v49, v34, v35
  v_cvt_pk_bf16_f32 v50, v36, v37
  v_cvt_pk_bf16_f32 v51, v38, v39
  v_exp_f32 v40, v40
  v_exp_f32 v41, v41
  v_exp_f32 v42, v42
  s_waitcnt lgkmcnt(3)
  v_mfma_f32_32x32x16_bf16 v[64:79], v[88:91], v[48:51], v[64:79]
  ds_read_b128 v[88:91], v12 offset:10240
  v_exp_f32 v43, v43
  v_exp_f32 v44, v44
  v_exp_f32 v45, v45
  v_exp_f32 v46, v46
  v_exp_f32 v47, v47
  v_cvt_pk_bf16_f32 v52, v40, v41
  v_cvt_pk_bf16_f32 v53, v42, v43
  v_cvt_pk_bf16_f32 v54, v44, v45
  v_cvt_pk_bf16_f32 v55, v46, v47
  s_waitcnt lgkmcnt(2)
  v_mfma_f32_32x32x16_bf16 v[32:47], v[80:83], v[4:7], 0
  v_exp_f32 v16, v16
  v_exp_f32 v17, v17
  v_exp_f32 v18, v18
  v_exp_f32 v19, v19
  v_mfma_f32_32x32x16_bf16 v[32:47], v[84:87], v[8:11], v[32:47]
  ds_read_b128 v[80:83], v13 offset:0
  ds_read_b128 v[84:87], v13 offset:1024
  v_exp_f32 v20, v20
  v_exp_f32 v21, v21
  v_exp_f32 v22, v22
  v_exp_f32 v23, v23
  s_waitcnt lgkmcnt(3)
  v_mfma_f32_32x32x16_bf16 v[64:79], v[92:95], v[52:55], v[64:79]
  ds_read_b128 v[92:95], v12 offset:11264
  v_cvt_pk_bf16_f32 v48, v16, v17
  v_cvt_pk_bf16_f32 v49, v18, v19
  v_cvt_pk_bf16_f32 v50, v20, v21
  v_cvt_pk_bf16_f32 v51, v22, v23
  v_exp_f32 v24, v24
  v_exp_f32 v25, v25
  v_exp_f32 v26, v26
  s_waitcnt lgkmcnt(3)
  v_mfma_f32_32x32x16_bf16 v[64:79], v[88:91], v[48:51], v[64:79]
  ds_read_b128 v[88:91], v12 offset:14336
  v_exp_f32 v27, v27
  v_exp_f32 v28, v28
  v_exp_f32 v29, v29
  v_exp_f32 v30, v30
  v_exp_f32 v31, v31
  v_cvt_pk_bf16_f32 v52, v24, v25
  v_cvt_pk_bf16_f32 v53, v26, v27
  v_cvt_pk_bf16_f32 v54, v28, v29
  v_cvt_pk_bf16_f32 v55, v30, v31
  s_waitcnt lgkmcnt(2)
  v_mfma_f32_32x32x16_bf16 v[16:31], v[80:83], v[4:7], 0
  v_exp_f32 v32, v32
  v_exp_f32 v33, v33
  v_exp_f32 v34, v34
  v_exp_f32 v35, v35
  v_mfma_f32_32x32x16_bf16 v[16:31], v[84:87], v[8:11], v[16:31]
  ds_read_b128 v[80:83], v13 offset:4096
  ds_read_b128 v[84:87], v13 offset:5120
  v_exp_f32 v36, v36
  v_exp_f32 v37, v37
  v_exp_f32 v38, v38
  v_exp_f32 v39, v39
  s_waitcnt lgkmcnt(3)
  v_mfma_f32_32x32x16_bf16 v[64:79], v[92:95], v[52:55], v[64:79]
  ds_read_b128 v[92:95], v12 offset:15360
  v_cvt_pk_bf16_f32 v48, v32, v33
  v_cvt_pk_bf16_f32 v49, v34, v35
  v_cvt_pk_bf16_f32 v50, v36, v37
  v_cvt_pk_bf16_f32 v51, v38, v39
  v_exp_f32 v40, v40
  v_exp_f32 v41, v41
  v_exp_f32 v42, v42
  s_waitcnt lgkmcnt(3)
  v_mfma_f32_32x32x16_bf16 v[64:79], v[88:91], v[48:51], v[64:79]
  ds_read_b128 v[88:91], v13 offset:2048
  v_exp_f32 v43, v43
  v_exp_f32 v44, v44
  v_exp_f32 v45, v45
  v_exp_f32 v46, v46
  v_exp_f32 v47, v47
  v_cvt_pk_bf16_f32 v52, v40, v41
  v_cvt_pk_bf16_f32 v53, v42, v43
  v_cvt_pk_bf16_f32 v54, v44, v45
  v_cvt_pk_bf16_f32 v55, v46, v47
  v_mov_b32 v12, v13
  v_add_u32 v13, 16384, v13
  v_and_b32 v13, 0xffff, v13
  s_add_u32 s25, s25, 1
  s_cmp_lt_u32 s25, 16
  s_waitcnt vmcnt(2)
  s_barrier
  s_cbranch_scc1 Lloop_k2_attn_kernel_4
  s_waitcnt lgkmcnt(0)
  v_mfma_f32_32x32x16_bf16 v[64:79], v[92:95], v[52:55], v[64:79]
  s_nop 15
  s_nop 3
  s_waitcnt lgkmcnt(0)
  s_nop 15
  v_mov_b32 v96, v72
  v_mov_b32 v97, v72
  s_nop 1
  v_permlane32_swap_b32 v96, v97
  s_nop 1
  v_rcp_f32 v97, v97
  s_nop 0
  v_mul_f32 v64, v64, v97
  v_mul_f32 v65, v65, v97
  v_mul_f32 v66, v66, v97
  v_mul_f32 v67, v67, v97
  v_mul_f32 v68, v68, v97
  v_mul_f32 v69, v69, v97
  v_mul_f32 v70, v70, v97
  v_mul_f32 v71, v71, v97
  v_mul_f32 v72, v72, v97
  v_mul_f32 v73, v73, v97
  v_mul_f32 v74, v74, v97
  v_mul_f32 v75, v75, v97
  v_cvt_pk_bf16_f32 v64, v64, v65
  v_cvt_pk_bf16_f32 v65, v66, v67
  v_cvt_pk_bf16_f32 v66, v68, v69
  v_cvt_pk_bf16_f32 v67, v70, v71
  v_cvt_pk_bf16_f32 v68, v72, v73
  v_cvt_pk_bf16_f32 v69, v74, v75
  v_lshl_add_u32 v98, v2, 3, v15
  v_lshl_add_u32 v99, v2, 30, v15
  buffer_store_dwordx2 v[64:65], v98, s[12:15], 0 offen
  buffer_store_dwordx2 v[66:67], v98, s[12:15], 0 offen offset:16
  buffer_store_dwordx2 v[68:69], v99, s[12:15], 0 offen offset:32
  s_endpgm
Lcs_k2_attn_kernel_1:
  s_cmp_ge_u32 s2, 310
  s_cbranch_scc1 Lpk_k2_attn_kernel_5
  s_sub_u32 s33, s2, 256
  s_waitcnt lgkmcnt(0)
  s_cmp_ge_u32 s33, 27
  s_cselect_b32 s20, s44, s42
  s_cselect_b32 s21, s45, s43
  s_mov_b32 s22, 2211840
  s_mov_b32 s23, 0x20000
  s_cselect_b32 s34, 27, 0
  s_sub_u32 s35, s33, s34
  s_lshl_b32 s35, s35, 7
  s_mul_i32 s34, s24, 276480
  s_add_u32 s35, s35, s34
  v_lshrrev_b32 v96, 3, v1
  v_mul_u32_u24 v96, 3456, v96
  v_and_b32 v97, 7, v1
  v_lshlrev_b32 v97, 4, v97
  v_add3_u32 v96, v96, v97, s35
  s_add_u32 s16, s40, 0x1000000
  s_addc_u32 s17, s41, 0
  s_mov_b32 s18, 0x3600
  s_mov_b32 s19, 0x20000
  v_mov_b32 v100, 0
  v_mov_b32 v101, 0
  v_mov_b32 v102, 0
  v_mov_b32 v103, 0
  v_mov_b32 v104, 0
  v_mov_b32 v105, 0
  v_mov_b32 v106, 0
  v_mov_b32 v107, 0
  s_mov_b32 s26, 0
  buffer_load_dwordx4 v[4:7], v96, s[20:23], s26 offen
  s_mov_b32 s26, 27648
  buffer_load_dwordx4 v[8:11], v96, s[20:23], s26 offen
  s_mov_b32 s26, 55296
  buffer_load_dwordx4 v[12:15], v96, s[20:23], s26 offen
  s_mov_b32 s26, 82944
  buffer_load_dwordx4 v[16:19], v96, s[20:23], s26 offen
  s_mov_b32 s26, 110592
  buffer_load_dwordx4 v[20:23], v96, s[20:23], s26 offen
  s_mov_b32 s26, 138240
  buffer_load_dwordx4 v[24:27], v96, s[20:23], s26 offen
  s_mov_b32 s26, 165888
  buffer_load_dwordx4 v[28:31], v96, s[20:23], s26 offen
  s_mov_b32 s26, 193536
  buffer_load_dwordx4 v[32:35], v96, s[20:23], s26 offen
  s_mov_b32 s26, 221184
  buffer_load_dwordx4 v[36:39], v96, s[20:23], s26 offen
  s_mov_b32 s26, 248832
  buffer_load_dwordx4 v[40:43], v96, s[20:23], s26 offen
  s_waitcnt vmcnt(9)
  v_lshlrev_b32 v98, 16, v4
  v_and_b32 v99, 0xffff0000, v4
  v_add_f32 v100, v100, v98
  v_add_f32 v101, v101, v99
  v_lshlrev_b32 v98, 16, v5
  v_and_b32 v99, 0xffff0000, v5
  v_add_f32 v102, v102, v98
  v_add_f32 v103, v103, v99
  v_lshlrev_b32 v98, 16, v6
  v_and_b32 v99, 0xffff0000, v6
  v_add_f32 v104, v104, v98
  v_add_f32 v105, v105, v99
  v_lshlrev_b32 v98, 16, v7
  v_and_b32 v99, 0xffff0000, v7
  v_add_f32 v106, v106, v98
  v_add_f32 v107, v107, v99
  s_waitcnt vmcnt(8)
  v_lshlrev_b32 v98, 16, v8
  v_and_b32 v99, 0xffff0000, v8
  v_add_f32 v100, v100, v98
  v_add_f32 v101, v101, v99
  v_lshlrev_b32 v98, 16, v9
  v_and_b32 v99, 0xffff0000, v9
  v_add_f32 v102, v102, v98
  v_add_f32 v103, v103, v99
  v_lshlrev_b32 v98, 16, v10
  v_and_b32 v99, 0xffff0000, v10
  v_add_f32 v104, v104, v98
  v_add_f32 v105, v105, v99
  v_lshlrev_b32 v98, 16, v11
  v_and_b32 v99, 0xffff0000, v11
  v_add_f32 v106, v106, v98
  v_add_f32 v107, v107, v99
  s_waitcnt vmcnt(7)
  v_lshlrev_b32 v98, 16, v12
  v_and_b32 v99, 0xffff0000, v12
  v_add_f32 v100, v100, v98
  v_add_f32 v101, v101, v99
  v_lshlrev_b32 v98, 16, v13
  v_and_b32 v99, 0xffff0000, v13
  v_add_f32 v102, v102, v98
  v_add_f32 v103, v103, v99
  v_lshlrev_b32 v98, 16, v14
  v_and_b32 v99, 0xffff0000, v14
  v_add_f32 v104, v104, v98
  v_add_f32 v105, v105, v99
  v_lshlrev_b32 v98, 16, v15
  v_and_b32 v99, 0xffff0000, v15
  v_add_f32 v106, v106, v98
  v_add_f32 v107, v107, v99
  s_waitcnt vmcnt(6)
  v_lshlrev_b32 v98, 16, v16
  v_and_b32 v99, 0xffff0000, v16
  v_add_f32 v100, v100, v98
  v_add_f32 v101, v101, v99
  v_lshlrev_b32 v98, 16, v17
  v_and_b32 v99, 0xffff0000, v17
  v_add_f32 v102, v102, v98
  v_add_f32 v103, v103, v99
  v_lshlrev_b32 v98, 16, v18
  v_and_b32 v99, 0xffff0000, v18
  v_add_f32 v104, v104, v98
  v_add_f32 v105, v105, v99
  v_lshlrev_b32 v98, 16, v19
  v_and_b32 v99, 0xffff0000, v19
  v_add_f32 v106, v106, v98
  v_add_f32 v107, v107, v99
  s_waitcnt vmcnt(5)
  v_lshlrev_b32 v98, 16, v20
  v_and_b32 v99, 0xffff0000, v20
  v_add_f32 v100, v100, v98
  v_add_f32 v101, v101, v99
  v_lshlrev_b32 v98, 16, v21
  v_and_b32 v99, 0xffff0000, v21
  v_add_f32 v102, v102, v98
  v_add_f32 v103, v103, v99
  v_lshlrev_b32 v98, 16, v22
  v_and_b32 v99, 0xffff0000, v22
  v_add_f32 v104, v104, v98
  v_add_f32 v105, v105, v99
  v_lshlrev_b32 v98, 16, v23
  v_and_b32 v99, 0xffff0000, v23
  v_add_f32 v106, v106, v98
  v_add_f32 v107, v107, v99
  s_waitcnt vmcnt(4)
  v_lshlrev_b32 v98, 16, v24
  v_and_b32 v99, 0xffff0000, v24
  v_add_f32 v100, v100, v98
  v_add_f32 v101, v101, v99
  v_lshlrev_b32 v98, 16, v25
  v_and_b32 v99, 0xffff0000, v25
  v_add_f32 v102, v102, v98
  v_add_f32 v103, v103, v99
  v_lshlrev_b32 v98, 16, v26
  v_and_b32 v99, 0xffff0000, v26
  v_add_f32 v104, v104, v98
  v_add_f32 v105, v105, v99
  v_lshlrev_b32 v98, 16, v27
  v_and_b32 v99, 0xffff0000, v27
  v_add_f32 v106, v106, v98
  v_add_f32 v107, v107, v99
  s_waitcnt vmcnt(3)
  v_lshlrev_b32 v98, 16, v28
  v_and_b32 v99, 0xffff0000, v28
  v_add_f32 v100, v100, v98
  v_add_f32 v101, v101, v99
  v_lshlrev_b32 v98, 16, v29
  v_and_b32 v99, 0xffff0000, v29
  v_add_f32 v102, v102, v98
  v_add_f32 v103, v103, v99
  v_lshlrev_b32 v98, 16, v30
  v_and_b32 v99, 0xffff0000, v30
  v_add_f32 v104, v104, v98
  v_add_f32 v105, v105, v99
  v_lshlrev_b32 v98, 16, v31
  v_and_b32 v99, 0xffff0000, v31
  v_add_f32 v106, v106, v98
  v_add_f32 v107, v107, v99
  s_waitcnt vmcnt(2)
  v_lshlrev_b32 v98, 16, v32
  v_and_b32 v99, 0xffff0000, v32
  v_add_f32 v100, v100, v98
  v_add_f32 v101, v101, v99
  v_lshlrev_b32 v98, 16, v33
  v_and_b32 v99, 0xffff0000, v33
  v_add_f32 v102, v102, v98
  v_add_f32 v103, v103, v99
  v_lshlrev_b32 v98, 16, v34
  v_and_b32 v99, 0xffff0000, v34
  v_add_f32 v104, v104, v98
  v_add_f32 v105, v105, v99
  v_lshlrev_b32 v98, 16, v35
  v_and_b32 v99, 0xffff0000, v35
  v_add_f32 v106, v106, v98
  v_add_f32 v107, v107, v99
  s_waitcnt vmcnt(1)
  v_lshlrev_b32 v98, 16, v36
  v_and_b32 v99, 0xffff0000, v36
  v_add_f32 v100, v100, v98
  v_add_f32 v101, v101, v99
  v_lshlrev_b32 v98, 16, v37
  v_and_b32 v99, 0xffff0000, v37
  v_add_f32 v102, v102, v98
  v_add_f32 v103, v103, v99
  v_lshlrev_b32 v98, 16, v38
  v_and_b32 v99, 0xffff0000, v38
  v_add_f32 v104, v104, v98
  v_add_f32 v105, v105, v99
  v_lshlrev_b32 v98, 16, v39
  v_and_b32 v99, 0xffff0000, v39
  v_add_f32 v106, v106, v98
  v_add_f32 v107, v107, v99
  s_waitcnt vmcnt(0)
  v_lshlrev_b32 v98, 16, v40
  v_and_b32 v99, 0xffff0000, v40
  v_add_f32 v100, v100, v98
  v_add_f32 v101, v101, v99
  v_lshlrev_b32 v98, 16, v41
  v_and_b32 v99, 0xffff0000, v41
  v_add_f32 v102, v102, v98
  v_add_f32 v103, v103, v99
  v_lshlrev_b32 v98, 16, v42
  v_and_b32 v99, 0xffff0000, v42
  v_add_f32 v104, v104, v98
  v_add_f32 v105, v105, v99
  v_lshlrev_b32 v98, 16, v43
  v_and_b32 v99, 0xffff0000, v43
  v_add_f32 v106, v106, v98
  v_add_f32 v107, v107, v99
  s_nop 1
  v_add_f32_dpp v100, v100, v100 row_ror:8 row_mask:0xf bank_mask:0xf
  v_mov_b32 v4, v100
  v_mov_b32 v5, v100
  s_nop 1
  v_permlane16_swap_b32 v4, v5
  s_nop 1
  v_add_f32 v100, v4, v5
  v_mov_b32 v4, v100
  v_mov_b32 v5, v100
  s_nop 1
  v_permlane32_swap_b32 v4, v5
  s_nop 1
  v_add_f32 v100, v4, v5
  s_nop 1
  v_add_f32_dpp v101, v101, v101 row_ror:8 row_mask:0xf bank_mask:0xf
  v_mov_b32 v4, v101
  v_mov_b32 v5, v101
  s_nop 1
  v_permlane16_swap_b32 v4, v5
  s_nop 1
  v_add_f32 v101, v4, v5
  v_mov_b32 v4, v101
  v_mov_b32 v5, v101
  s_nop 1
  v_permlane32_swap_b32 v4, v5
  s_nop 1
  v_add_f32 v101, v4, v5
  s_nop 1
  v_add_f32_dpp v102, v102, v102 row_ror:8 row_mask:0xf bank_mask:0xf
  v_mov_b32 v4, v102
  v_mov_b32 v5, v102
  s_nop 1
  v_permlane16_swap_b32 v4, v5
  s_nop 1
  v_add_f32 v102, v4, v5
  v_mov_b32 v4, v102
  v_mov_b32 v5, v102
  s_nop 1
  v_permlane32_swap_b32 v4, v5
  s_nop 1
  v_add_f32 v102, v4, v5
  s_nop 1
  v_add_f32_dpp v103, v103, v103 row_ror:8 row_mask:0xf bank_mask:0xf
  v_mov_b32 v4, v103
  v_mov_b32 v5, v103
  s_nop 1
  v_permlane16_swap_b32 v4, v5
  s_nop 1
  v_add_f32 v103, v4, v5
  v_mov_b32 v4, v103
  v_mov_b32 v5, v103
  s_nop 1
  v_permlane32_swap_b32 v4, v5
  s_nop 1
  v_add_f32 v103, v4, v5
  s_nop 1
  v_add_f32_dpp v104, v104, v104 row_ror:8 row_mask:0xf bank_mask:0xf
  v_mov_b32 v4, v104
  v_mov_b32 v5, v104
  s_nop 1
  v_permlane16_swap_b32 v4, v5
  s_nop 1
  v_add_f32 v104, v4, v5
  v_mov_b32 v4, v104
  v_mov_b32 v5, v104
  s_nop 1
  v_permlane32_swap_b32 v4, v5
  s_nop 1
  v_add_f32 v104, v4, v5
  s_nop 1
  v_add_f32_dpp v105, v105, v105 row_ror:8 row_mask:0xf bank_mask:0xf
  v_mov_b32 v4, v105
  v_mov_b32 v5, v105
  s_nop 1
  v_permlane16_swap_b32 v4, v5
  s_nop 1
  v_add_f32 v105, v4, v5
  v_mov_b32 v4, v105
  v_mov_b32 v5, v105
  s_nop 1
  v_permlane32_swap_b32 v4, v5
  s_nop 1
  v_add_f32 v105, v4, v5
  s_nop 1
  v_add_f32_dpp v106, v106, v106 row_ror:8 row_mask:0xf bank_mask:0xf
  v_mov_b32 v4, v106
  v_mov_b32 v5, v106
  s_nop 1
  v_permlane16_swap_b32 v4, v5
  s_nop 1
  v_add_f32 v106, v4, v5
  v_mov_b32 v4, v106
  v_mov_b32 v5, v106
  s_nop 1
  v_permlane32_swap_b32 v4, v5
  s_nop 1
  v_add_f32 v106, v4, v5
  s_nop 1
  v_add_f32_dpp v107, v107, v107 row_ror:8 row_mask:0xf bank_mask:0xf
  v_mov_b32 v4, v107
  v_mov_b32 v5, v107
  s_nop 1
  v_permlane16_swap_b32 v4, v5
  s_nop 1
  v_add_f32 v107, v4, v5
  v_mov_b32 v4, v107
  v_mov_b32 v5, v107
  s_nop 1
  v_permlane32_swap_b32 v4, v5
  s_nop 1
  v_add_f32 v107, v4, v5
  s_lshl_b32 s34, s24, 8
  v_lshlrev_b32 v4, 5, v1
  v_add_u32 v4, s34, v4
  v_cmp_gt_u32 vcc, 8, v1
  s_and_saveexec_b64 s[52:53], vcc
  ds_write_b128 v4, v[100:103]
  ds_write_b128 v4, v[104:107] offset:16
  s_mov_b64 exec, s[52:53]
  s_waitcnt lgkmcnt(0)
  s_barrier
  s_cmp_lg_u32 s24, 0
  s_cbranch_scc1 L_k2_attn_kernel_end
  v_lshlrev_b32 v4, 2, v1
  ds_read_b32 v8, v4 offset:0
  ds_read_b32 v9, v4 offset:256
  ds_read_b32 v10, v4 offset:512
  ds_read_b32 v11, v4 offset:768
  ds_read_b32 v12, v4 offset:1024
  ds_read_b32 v13, v4 offset:1280
  ds_read_b32 v14, v4 offset:1536
  ds_read_b32 v15, v4 offset:1792
  s_waitcnt lgkmcnt(0)
  v_add_f32 v8, v8, v9
  v_add_f32 v8, v8, v10
  v_add_f32 v8, v8, v11
  v_add_f32 v8, v8, v12
  v_add_f32 v8, v8, v13
  v_add_f32 v8, v8, v14
  v_add_f32 v8, v8, v15
  s_lshl_b32 s33, s33, 8
  v_add_u32 v4, s33, v4
  buffer_store_dword v8, v4, s[16:19], 0 offen
  s_endpgm
Lpk_k2_attn_kernel_5:
  s_load_dwordx2 s[46:47], s[0:1], 32
  s_load_dwordx2 s[48:49], s[0:1], 64
  s_movk_i32 s33, 6554
  v_add_u32 v96, 0, v1
  v_mul_u32_u24 v97, s33, v96
  v_lshrrev_b32 v97, 16, v97
  v_mul_u32_u24 v98, 10, v97
  v_sub_u32 v98, v96, v98
  v_lshrrev_b32 v99, 1, v97
  v_and_b32 v99, 4, v99
  v_xor_b32 v97, v97, v99
  v_mul_u32_u24 v97, 1280, v97
  v_lshlrev_b32 v98, 4, v98
  v_add3_u32 v4, v97, v98, 0
  v_add_u32 v96, 64, v1
  v_mul_u32_u24 v97, s33, v96
  v_lshrrev_b32 v97, 16, v97
  v_mul_u32_u24 v98, 10, v97
  v_sub_u32 v98, v96, v98
  v_lshrrev_b32 v99, 1, v97
  v_and_b32 v99, 4, v99
  v_xor_b32 v97, v97, v99
  v_mul_u32_u24 v97, 1280, v97
  v_lshlrev_b32 v98, 4, v98
  v_add3_u32 v5, v97, v98, 0
  v_add_u32 v96, 128, v1
  v_mul_u32_u24 v97, s33, v96
  v_lshrrev_b32 v97, 16, v97
  v_mul_u32_u24 v98, 10, v97
  v_sub_u32 v98, v96, v98
  v_lshrrev_b32 v99, 1, v97
  v_and_b32 v99, 4, v99
  v_xor_b32 v97, v97, v99
  v_mul_u32_u24 v97, 1280, v97
  v_lshlrev_b32 v98, 4, v98
  v_add3_u32 v6, v97, v98, 0
  v_add_u32 v96, 192, v1
  v_mul_u32_u24 v97, s33, v96
  v_lshrrev_b32 v97, 16, v97
  v_mul_u32_u24 v98, 10, v97
  v_sub_u32 v98, v96, v98
  v_lshrrev_b32 v99, 1, v97
  v_and_b32 v99, 4, v99
  v_xor_b32 v97, v97, v99
  v_mul_u32_u24 v97, 1280, v97
  v_lshlrev_b32 v98, 4, v98
  v_add3_u32 v7, v97, v98, 0
  v_add_u32 v96, 256, v1
  v_mul_u32_u24 v97, s33, v96
  v_lshrrev_b32 v97, 16, v97
  v_mul_u32_u24 v98, 10, v97
  v_sub_u32 v98, v96, v98
  v_lshrrev_b32 v99, 1, v97
  v_and_b32 v99, 4, v99
  v_xor_b32 v97, v97, v99
  v_mul_u32_u24 v97, 1280, v97
  v_lshlrev_b32 v98, 4, v98
  v_add3_u32 v8, v97, v98, 0
  s_movk_i32 s33, 4682
  v_add_u32 v96, 0, v1
  v_mul_u32_u24 v97, s33, v96
  v_lshrrev_b32 v97, 16, v97
  v_mul_u32_u24 v98, 14, v97
  v_sub_u32 v98, v96, v98
  v_lshrrev_b32 v99, 1, v97
  v_and_b32 v99, 4, v99
  v_xor_b32 v97, v97, v99
  v_mul_u32_u24 v97, 3456, v97
  v_lshlrev_b32 v98, 4, v98
  v_add3_u32 v9, v97, v98, 0
  v_add_u32 v96, 64, v1
  v_mul_u32_u24 v97, s33, v96
  v_lshrrev_b32 v97, 16, v97
  v_mul_u32_u24 v98, 14, v97
  v_sub_u32 v98, v96, v98
  v_lshrrev_b32 v99, 1, v97
  v_and_b32 v99, 4, v99
  v_xor_b32 v97, v97, v99
  v_mul_u32_u24 v97, 3456, v97
  v_lshlrev_b32 v98, 4, v98
  v_add3_u32 v10, v97, v98, 0
  v_add_u32 v96, 128, v1
  v_mul_u32_u24 v97, s33, v96
  v_lshrrev_b32 v97, 16, v97
  v_mul_u32_u24 v98, 14, v97
  v_sub_u32 v98, v96, v98
  v_lshrrev_b32 v99, 1, v97
  v_and_b32 v99, 4, v99
  v_xor_b32 v97, v97, v99
  v_mul_u32_u24 v97, 3456, v97
  v_lshlrev_b32 v98, 4, v98
  v_add3_u32 v11, v97, v98, 0
  v_add_u32 v96, 192, v1
  v_mul_u32_u24 v97, s33, v96
  v_lshrrev_b32 v97, 16, v97
  v_mul_u32_u24 v98, 14, v97
  v_sub_u32 v98, v96, v98
  v_lshrrev_b32 v99, 1, v97
  v_and_b32 v99, 4, v99
  v_xor_b32 v97, v97, v99
  v_mul_u32_u24 v97, 3456, v97
  v_lshlrev_b32 v98, 4, v98
  v_add3_u32 v12, v97, v98, 0
  v_add_u32 v96, 256, v1
  v_mul_u32_u24 v97, s33, v96
  v_lshrrev_b32 v97, 16, v97
  v_mul_u32_u24 v98, 14, v97
  v_sub_u32 v98, v96, v98
  v_lshrrev_b32 v99, 1, v97
  v_and_b32 v99, 4, v99
  v_xor_b32 v97, v97, v99
  v_mul_u32_u24 v97, 3456, v97
  v_lshlrev_b32 v98, 4, v98
  v_add3_u32 v13, v97, v98, 0
  v_add_u32 v96, 320, v1
  v_mul_u32_u24 v97, s33, v96
  v_lshrrev_b32 v97, 16, v97
  v_mul_u32_u24 v98, 14, v97
  v_sub_u32 v98, v96, v98
  v_lshrrev_b32 v99, 1, v97
  v_and_b32 v99, 4, v99
  v_xor_b32 v97, v97, v99
  v_mul_u32_u24 v97, 3456, v97
  v_lshlrev_b32 v98, 4, v98
  v_add3_u32 v14, v97, v98, 0
  v_add_u32 v96, 384, v1
  v_mul_u32_u24 v97, s33, v96
  v_lshrrev_b32 v97, 16, v97
  v_mul_u32_u24 v98, 14, v97
  v_sub_u32 v98, v96, v98
  v_lshrrev_b32 v99, 1, v97
  v_and_b32 v99, 4, v99
  v_xor_b32 v97, v97, v99
  v_mul_u32_u24 v97, 3456, v97
  v_lshlrev_b32 v98, 4, v98
  v_add3_u32 v15, v97, v98, 0
  v_lshlrev_b32 v44, 4, v1
  s_sub_u32 s28, s2, 310
  s_lshl_b32 s28, s28, 3
  s_add_u32 s28, s28, s24
  s_waitcnt lgkmcnt(0)
  s_add_u32 s12, s40, 0x1100000
  s_addc_u32 s13, s41, 0
  s_mov_b32 s14, 0x1000000
  s_mov_b32 s15, 0x20000
L_k2_attn_kernel_6:
  s_and_b32 s31, s28, 3
  s_cmp_ge_u32 s28, 768
  s_cbranch_scc1 L_k2_attn_kernel_9
  s_cmp_ge_u32 s28, 256
  s_cbranch_scc1 L_k2_attn_kernel_8
  s_bfe_u32 s30, s28, 0x30002
  s_lshr_b32 s29, s28, 5
  s_cmp_ge_u32 s30, 5
  s_cbranch_scc1 L_k2_attn_kernel_7
  s_mul_i32 s35, s29, 5
  s_add_u32 s35, s35, s30
  s_mul_i32 s35, s35, 20480
  s_mov_b32 s20, s46
  s_mov_b32 s21, s47
  s_mov_b32 s22, 0xc8000
  s_mov_b32 s23, 0x20000
  s_branch L_k2_attn_kernel_10
L_k2_attn_kernel_8:
  s_sub_u32 s33, s28, 256
  s_bfe_u32 s30, s33, 0x40002
  s_lshr_b32 s29, s33, 6
  s_cmp_ge_u32 s30, 14
  s_cbranch_scc1 L_k2_attn_kernel_7
  s_mul_i32 s35, s29, 14
  s_add_u32 s35, s35, s30
  s_mul_i32 s35, s35, 20480
  s_add_u32 s35, s35, 1048576
  s_mov_b32 s20, s48
  s_mov_b32 s21, s49
  s_mov_b32 s22, 0x21c000
  s_mov_b32 s23, 0x20000
L_k2_attn_kernel_10:
  s_mul_i32 s33, s31, 5120
  s_add_u32 s35, s35, s33
  s_lshl_b32 s34, s30, 2
  s_add_u32 s34, s34, s31
  s_mul_i32 s34, s34, 40960
  s_mul_i32 s33, s29, 160
  s_add_u32 s34, s34, s33
  v_add_u32 v96, s34, v4
  buffer_load_dwordx4 v[16:19], v96, s[20:23], 0 offen
  v_add_u32 v97, s34, v5
  buffer_load_dwordx4 v[20:23], v97, s[20:23], 0 offen
  v_add_u32 v98, s34, v6
  buffer_load_dwordx4 v[24:27], v98, s[20:23], 0 offen
  v_add_u32 v99, s34, v7
  buffer_load_dwordx4 v[28:31], v99, s[20:23], 0 offen
  v_add_u32 v100, s34, v8
  buffer_load_dwordx4 v[32:35], v100, s[20:23], 0 offen
  v_add_u32 v104, s35, v44
  s_waitcnt vmcnt(0)
  s_mov_b32 s33, 0
  buffer_store_dwordx4 v[16:19], v104, s[12:15], s33 offen
  s_mov_b32 s33, 1024
  buffer_store_dwordx4 v[20:23], v104, s[12:15], s33 offen
  s_mov_b32 s33, 2048
  buffer_store_dwordx4 v[24:27], v104, s[12:15], s33 offen
  s_mov_b32 s33, 3072
  buffer_store_dwordx4 v[28:31], v104, s[12:15], s33 offen
  s_mov_b32 s33, 4096
  buffer_store_dwordx4 v[32:35], v104, s[12:15], s33 offen
  s_waitcnt vmcnt(0)
  s_branch L_k2_attn_kernel_7
L_k2_attn_kernel_9:
  s_sub_u32 s33, s28, 768
  s_bfe_u32 s30, s33, 0x40002
  s_lshr_b32 s29, s33, 6
  s_cmp_ge_u32 s30, 10
  s_cbranch_scc1 L_k2_attn_kernel_7
  s_mul_i32 s35, s29, 10
  s_add_u32 s35, s35, s30
  s_mul_i32 s35, s35, 28672
  s_mul_i32 s33, s31, 7168
  s_add_u32 s35, s35, s33
  s_add_u32 s35, s35, 4194304
  s_bitcmp1_b32 s31, 1
  s_cselect_b32 s20, s44, s42
  s_cselect_b32 s21, s45, s43
  s_mov_b32 s22, 2211840
  s_mov_b32 s23, 0x20000
  s_and_b32 s33, s31, 1
  s_lshl_b32 s34, s30, 1
  s_add_u32 s34, s34, s33
  s_mul_i32 s34, s34, 110592
  s_mul_i32 s33, s29, 224
  s_add_u32 s34, s34, s33
  v_add_u32 v96, s34, v9
  buffer_load_dwordx4 v[16:19], v96, s[20:23], 0 offen
  v_add_u32 v97, s34, v10
  buffer_load_dwordx4 v[20:23], v97, s[20:23], 0 offen
  v_add_u32 v98, s34, v11
  buffer_load_dwordx4 v[24:27], v98, s[20:23], 0 offen
  v_add_u32 v99, s34, v12
  buffer_load_dwordx4 v[28:31], v99, s[20:23], 0 offen
  v_add_u32 v100, s34, v13
  buffer_load_dwordx4 v[32:35], v100, s[20:23], 0 offen
  v_add_u32 v101, s34, v14
  buffer_load_dwordx4 v[36:39], v101, s[20:23], 0 offen
  v_add_u32 v102, s34, v15
  buffer_load_dwordx4 v[40:43], v102, s[20:23], 0 offen
  v_add_u32 v104, s35, v44
  s_waitcnt vmcnt(0)
  s_mov_b32 s33, 0
  buffer_store_dwordx4 v[16:19], v104, s[12:15], s33 offen
  s_mov_b32 s33, 1024
  buffer_store_dwordx4 v[20:23], v104, s[12:15], s33 offen
  s_mov_b32 s33, 2048
  buffer_store_dwordx4 v[24:27], v104, s[12:15], s33 offen
  s_mov_b32 s33, 3072
  buffer_store_dwordx4 v[28:31], v104, s[12:15], s33 offen
  s_mov_b32 s33, 4096
  buffer_store_dwordx4 v[32:35], v104, s[12:15], s33 offen
  s_mov_b32 s33, 5120
  buffer_store_dwordx4 v[36:39], v104, s[12:15], s33 offen
  s_mov_b32 s33, 6144
  buffer_store_dwordx4 v[40:43], v104, s[12:15], s33 offen
  s_waitcnt vmcnt(0)
L_k2_attn_kernel_7:
  s_add_u32 s28, s28, 448
  s_cmp_lt_u32 s28, 1792
  s_cbranch_scc1 L_k2_attn_kernel_6
L_k2_attn_kernel_end:
  s_endpgm
.globl k3_wo_kernel
.p2align 8
.type k3_wo_kernel,@function
k3_wo_kernel:
  s_cmp_ge_u32 s2, 256
  s_cbranch_scc1 L_k3_wo_kernel_end
  s_load_dwordx2 s[44:45], s[0:1], 88
  s_load_dwordx2 s[40:41], s[0:1], 0
  v_and_b32 v1, 63, v0
  v_lshrrev_b32 v22, 6, v0
  v_lshrrev_b32 v2, 4, v1
  v_readfirstlane_b32 s24, v22
  v_and_b32 v3, 15, v1
  s_and_b32 s33, s2, 7
  s_lshr_b32 s26, s2, 3
  s_lshl_b32 s25, s33, 2
  s_lshr_b32 s33, s26, 3
  s_add_u32 s25, s25, s33
  s_and_b32 s26, s26, 7
  s_cmp_eq_u32 s24, 4
  s_cbranch_scc1 L_k3_wo_kernel_1
  s_cmp_eq_u32 s24, 5
  s_cbranch_scc1 L_k3_wo_kernel_2
  s_waitcnt lgkmcnt(0)
  s_add_u32 s4, s44, 0x300000
  s_addc_u32 s5, s45, 0
  s_mov_b32 s6, 0x280000
  s_mov_b32 s7, 0x20000
  s_add_u32 s8, s44, 0x1100000
  s_addc_u32 s9, s45, 0
  s_mov_b32 s10, 0xc8000
  s_mov_b32 s11, 0x20000
  s_mov_b32 s12, s40
  s_mov_b32 s13, s41
  s_mov_b32 s14, 0x280000
  s_mov_b32 s15, 0x20000
  s_add_u32 s16, s44, 0x600000
  s_addc_u32 s17, s45, 0
  s_mov_b32 s18, 0x280000
  s_mov_b32 s19, 0x20000
  s_and_b32 s33, s24, 1
  s_lshl_b32 s33, s33, 13
  v_xor_b32 v22, v2, v3
  v_lshlrev_b32 v23, 8, v3
  v_add_u32 v23, s33, v23
  v_xor_b32 v24, 0, v22
  v_lshl_add_u32 v14, v24, 4, v23
  v_xor_b32 v24, 4, v22
  v_lshl_add_u32 v15, v24, 4, v23
  v_xor_b32 v24, 8, v22
  v_lshl_add_u32 v16, v24, 4, v23
  v_xor_b32 v24, 12, v22
  v_lshl_add_u32 v17, v24, 4, v23
  v_lshrrev_b32 v22, 2, v1
  v_and_b32 v22, 3, v22
  v_and_b32 v23, 1, v2
  v_lshlrev_b32 v23, 2, v23
  v_xor_b32 v22, v22, v23
  v_lshl_add_u32 v22, v2, 3, v22
  v_xor_b32 v23, 4, v22
  v_and_b32 v24, 3, v1
  v_lshlrev_b32 v24, 3, v24
  v_mul_u32_u24 v18, 160, v22
  v_mul_u32_u24 v19, 160, v23
  v_add3_u32 v18, v18, v24, 0
  v_add_u32 v19, v19, v24
  v_add_u32 v18, 16384, v18
  v_add_u32 v19, 16384, v19
  s_lshl_b32 s33, s25, 6
  s_and_b32 s34, s24, 1
  s_lshl_b32 s34, s34, 5
  s_add_u32 s33, s33, s34
  v_add_u32 v22, s33, v3
  v_mul_u32_u24 v128, 1280, v22
  s_mul_i32 s33, s26, 160
  s_lshr_b32 s34, s24, 1
  s_mul_i32 s34, s34, 96
  s_add_u32 s33, s33, s34
  v_lshlrev_b32 v22, 3, v2
  v_add3_u32 v128, v128, v22, s33
  v_mov_b32 v72, 0
  v_mov_b32 v73, 0
  v_mov_b32 v74, 0
  v_mov_b32 v75, 0
  v_mov_b32 v76, 0
  v_mov_b32 v77, 0
  v_mov_b32 v78, 0
  v_mov_b32 v79, 0
  v_mov_b32 v80, 0
  v_mov_b32 v81, 0
  v_mov_b32 v82, 0
  v_mov_b32 v83, 0
  v_mov_b32 v84, 0
  v_mov_b32 v85, 0
  v_mov_b32 v86, 0
  v_mov_b32 v87, 0
  v_mov_b32 v88, 0
  v_mov_b32 v89, 0
  v_mov_b32 v90, 0
  v_mov_b32 v91, 0
  v_mov_b32 v92, 0
  v_mov_b32 v93, 0
  v_mov_b32 v94, 0
  v_mov_b32 v95, 0
  s_mov_b32 s35, 0
  s_mov_b32 s36, 20480
  s_cmp_ge_u32 s24, 2
  s_cbranch_scc1 L_k3_wo_kernel_3
  s_mov_b32 s56, 0
  s_mov_b32 s57, 0
  s_mov_b32 s59, 36864
L_k3_wo_kernel_4:
  s_barrier
  v_add_u32 v14, s57, v14
  v_add_u32 v15, s57, v15
  v_add_u32 v16, s57, v16
  v_add_u32 v17, s57, v17
  v_add_u32 v18, s57, v18
  v_add_u32 v19, s57, v19
  ds_read_b128 v[32:35], v14 offset:0
  ds_read_b128 v[36:39], v14 offset:4096
  ds_read_b64_tr_b16 v[48:49], v18 offset:0
  ds_read_b64_tr_b16 v[50:51], v19 offset:0
  ds_read_b64_tr_b16 v[52:53], v18 offset:32
  ds_read_b64_tr_b16 v[54:55], v19 offset:32
  ds_read_b64_tr_b16 v[56:57], v18 offset:64
  ds_read_b64_tr_b16 v[58:59], v19 offset:64
  ds_read_b128 v[40:43], v15 offset:0
  ds_read_b128 v[44:47], v15 offset:4096
  ds_read_b64_tr_b16 v[60:61], v18 offset:5120
  ds_read_b64_tr_b16 v[62:63], v19 offset:5120
  ds_read_b64_tr_b16 v[64:65], v18 offset:5152
  ds_read_b64_tr_b16 v[66:67], v19 offset:5152
  ds_read_b64_tr_b16 v[68:69], v18 offset:5184
  ds_read_b64_tr_b16 v[70:71], v19 offset:5184
  s_waitcnt lgkmcnt(8)
  v_mfma_f32_16x16x32_bf16 v[72:75], v[48:51], v[32:35], v[72:75]
  v_mfma_f32_16x16x32_bf16 v[76:79], v[48:51], v[36:39], v[76:79]
  v_mfma_f32_16x16x32_bf16 v[80:83], v[52:55], v[32:35], v[80:83]
  v_mfma_f32_16x16x32_bf16 v[84:87], v[52:55], v[36:39], v[84:87]
  v_mfma_f32_16x16x32_bf16 v[88:91], v[56:59], v[32:35], v[88:91]
  v_mfma_f32_16x16x32_bf16 v[92:95], v[56:59], v[36:39], v[92:95]
  ds_read_b128 v[32:35], v16 offset:0
  ds_read_b128 v[36:39], v16 offset:4096
  ds_read_b64_tr_b16 v[48:49], v18 offset:10240
  ds_read_b64_tr_b16 v[50:51], v19 offset:10240
  ds_read_b64_tr_b16 v[52:53], v18 offset:10272
  ds_read_b64_tr_b16 v[54:55], v19 offset:10272
  ds_read_b64_tr_b16 v[56:57], v18 offset:10304
  ds_read_b64_tr_b16 v[58:59], v19 offset:10304
  s_waitcnt lgkmcnt(8)
  v_mfma_f32_16x16x32_bf16 v[72:75], v[60:63], v[40:43], v[72:75]
  v_mfma_f32_16x16x32_bf16 v[76:79], v[60:63], v[44:47], v[76:79]
  v_mfma_f32_16x16x32_bf16 v[80:83], v[64:67], v[40:43], v[80:83]
  v_mfma_f32_16x16x32_bf16 v[84:87], v[64:67], v[44:47], v[84:87]
  v_mfma_f32_16x16x32_bf16 v[88:91], v[68:71], v[40:43], v[88:91]
  v_mfma_f32_16x16x32_bf16 v[92:95], v[68:71], v[44:47], v[92:95]
  ds_read_b128 v[40:43], v17 offset:0
  ds_read_b128 v[44:47], v17 offset:4096
  ds_read_b64_tr_b16 v[60:61], v18 offset:15360
  ds_read_b64_tr_b16 v[62:63], v19 offset:15360
  ds_read_b64_tr_b16 v[64:65], v18 offset:15392
  ds_read_b64_tr_b16 v[66:67], v19 offset:15392
  ds_read_b64_tr_b16 v[68:69], v18 offset:15424
  ds_read_b64_tr_b16 v[70:71], v19 offset:15424
  s_waitcnt lgkmcnt(8)
  v_mfma_f32_16x16x32_bf16 v[72:75], v[48:51], v[32:35], v[72:75]
  v_mfma_f32_16x16x32_bf16 v[76:79], v[48:51], v[36:39], v[76:79]
  v_mfma_f32_16x16x32_bf16 v[80:83], v[52:55], v[32:35], v[80:83]
  v_mfma_f32_16x16x32_bf16 v[84:87], v[52:55], v[36:39], v[84:87]
  v_mfma_f32_16x16x32_bf16 v[88:91], v[56:59], v[32:35], v[88:91]
  v_mfma_f32_16x16x32_bf16 v[92:95], v[56:59], v[36:39], v[92:95]
  s_waitcnt lgkmcnt(0)
  v_mfma_f32_16x16x32_bf16 v[72:75], v[60:63], v[40:43], v[72:75]
  v_mfma_f32_16x16x32_bf16 v[76:79], v[60:63], v[44:47], v[76:79]
  v_mfma_f32_16x16x32_bf16 v[80:83], v[64:67], v[40:43], v[80:83]
  v_mfma_f32_16x16x32_bf16 v[84:87], v[64:67], v[44:47], v[84:87]
  v_mfma_f32_16x16x32_bf16 v[88:91], v[68:71], v[40:43], v[88:91]
  v_mfma_f32_16x16x32_bf16 v[92:95], v[68:71], v[44:47], v[92:95]
  s_cmp_eq_u32 s56, 1
  s_cbranch_scc0 L_k3_wo_kernel_5
  buffer_load_dwordx2 v[116:117], v128, s[12:15], s35 offen offset:0
  buffer_load_dwordx2 v[118:119], v128, s[12:15], s36 offen offset:0
  buffer_load_dwordx2 v[120:121], v128, s[12:15], s35 offen offset:32
  buffer_load_dwordx2 v[122:123], v128, s[12:15], s36 offen offset:32
  buffer_load_dwordx2 v[124:125], v128, s[12:15], s35 offen offset:64
  buffer_load_dwordx2 v[126:127], v128, s[12:15], s36 offen offset:64
L_k3_wo_kernel_5:
  s_add_u32 s56, s56, 1
  s_and_b32 s33, s56, 3
  s_cmp_eq_u32 s33, 0
  s_cselect_b32 s57, -110592, s59
  s_cmp_lt_u32 s56, 5
  s_cbranch_scc1 L_k3_wo_kernel_4
  s_waitcnt vmcnt(0)
  s_nop 7
  s_nop 7
  v_lshlrev_b32 v22, 16, v116
  v_and_b32 v23, 0xffff0000, v116
  v_lshlrev_b32 v24, 16, v117
  v_and_b32 v25, 0xffff0000, v117
  v_add_f32 v72, v72, v22
  v_add_f32 v73, v73, v23
  v_add_f32 v74, v74, v24
  v_add_f32 v75, v75, v25
  v_cvt_pk_bf16_f32 v72, v72, v73
  v_cvt_pk_bf16_f32 v73, v74, v75
  buffer_store_dwordx2 v[72:73], v128, s[16:19], s35 offen offset:0
  v_lshlrev_b32 v22, 16, v118
  v_and_b32 v23, 0xffff0000, v118
  v_lshlrev_b32 v24, 16, v119
  v_and_b32 v25, 0xffff0000, v119
  v_add_f32 v76, v76, v22
  v_add_f32 v77, v77, v23
  v_add_f32 v78, v78, v24
  v_add_f32 v79, v79, v25
  v_cvt_pk_bf16_f32 v76, v76, v77
  v_cvt_pk_bf16_f32 v77, v78, v79
  buffer_store_dwordx2 v[76:77], v128, s[16:19], s36 offen offset:0
  v_lshlrev_b32 v22, 16, v120
  v_and_b32 v23, 0xffff0000, v120
  v_lshlrev_b32 v24, 16, v121
  v_and_b32 v25, 0xffff0000, v121
  v_add_f32 v80, v80, v22
  v_add_f32 v81, v81, v23
  v_add_f32 v82, v82, v24
  v_add_f32 v83, v83, v25
  v_cvt_pk_bf16_f32 v80, v80, v81
  v_cvt_pk_bf16_f32 v81, v82, v83
  buffer_store_dwordx2 v[80:81], v128, s[16:19], s35 offen offset:32
  v_lshlrev_b32 v22, 16, v122
  v_and_b32 v23, 0xffff0000, v122
  v_lshlrev_b32 v24, 16, v123
  v_and_b32 v25, 0xffff0000, v123
  v_add_f32 v84, v84, v22
  v_add_f32 v85, v85, v23
  v_add_f32 v86, v86, v24
  v_add_f32 v87, v87, v25
  v_cvt_pk_bf16_f32 v84, v84, v85
  v_cvt_pk_bf16_f32 v85, v86, v87
  buffer_store_dwordx2 v[84:85], v128, s[16:19], s36 offen offset:32
  v_lshlrev_b32 v22, 16, v124
  v_and_b32 v23, 0xffff0000, v124
  v_lshlrev_b32 v24, 16, v125
  v_and_b32 v25, 0xffff0000, v125
  v_add_f32 v88, v88, v22
  v_add_f32 v89, v89, v23
  v_add_f32 v90, v90, v24
  v_add_f32 v91, v91, v25
  v_cvt_pk_bf16_f32 v88, v88, v89
  v_cvt_pk_bf16_f32 v89, v90, v91
  buffer_store_dwordx2 v[88:89], v128, s[16:19], s35 offen offset:64
  v_lshlrev_b32 v22, 16, v126
  v_and_b32 v23, 0xffff0000, v126
  v_lshlrev_b32 v24, 16, v127
  v_and_b32 v25, 0xffff0000, v127
  v_add_f32 v92, v92, v22
  v_add_f32 v93, v93, v23
  v_add_f32 v94, v94, v24
  v_add_f32 v95, v95, v25
  v_cvt_pk_bf16_f32 v92, v92, v93
  v_cvt_pk_bf16_f32 v93, v94, v95
  buffer_store_dwordx2 v[92:93], v128, s[16:19], s36 offen offset:64
  s_endpgm
L_k3_wo_kernel_3:
  s_mov_b32 s56, 0
  s_mov_b32 s57, 0
  s_mov_b32 s59, 36864
L_k3_wo_kernel_6:
  s_barrier
  v_add_u32 v14, s57, v14
  v_add_u32 v15, s57, v15
  v_add_u32 v16, s57, v16
  v_add_u32 v17, s57, v17
  v_add_u32 v18, s57, v18
  v_add_u32 v19, s57, v19
  ds_read_b128 v[32:35], v14 offset:0
  ds_read_b128 v[36:39], v14 offset:4096
  ds_read_b64_tr_b16 v[48:49], v18 offset:96
  ds_read_b64_tr_b16 v[50:51], v19 offset:96
  ds_read_b64_tr_b16 v[52:53], v18 offset:128
  ds_read_b64_tr_b16 v[54:55], v19 offset:128
  ds_read_b128 v[40:43], v15 offset:0
  ds_read_b128 v[44:47], v15 offset:4096
  ds_read_b64_tr_b16 v[60:61], v18 offset:5216
  ds_read_b64_tr_b16 v[62:63], v19 offset:5216
  ds_read_b64_tr_b16 v[64:65], v18 offset:5248
  ds_read_b64_tr_b16 v[66:67], v19 offset:5248
  s_waitcnt lgkmcnt(6)
  v_mfma_f32_16x16x32_bf16 v[72:75], v[48:51], v[32:35], v[72:75]
  v_mfma_f32_16x16x32_bf16 v[76:79], v[48:51], v[36:39], v[76:79]
  v_mfma_f32_16x16x32_bf16 v[80:83], v[52:55], v[32:35], v[80:83]
  v_mfma_f32_16x16x32_bf16 v[84:87], v[52:55], v[36:39], v[84:87]
  ds_read_b128 v[32:35], v16 offset:0
  ds_read_b128 v[36:39], v16 offset:4096
  ds_read_b64_tr_b16 v[48:49], v18 offset:10336
  ds_read_b64_tr_b16 v[50:51], v19 offset:10336
  ds_read_b64_tr_b16 v[52:53], v18 offset:10368
  ds_read_b64_tr_b16 v[54:55], v19 offset:10368
  s_waitcnt lgkmcnt(6)
  v_mfma_f32_16x16x32_bf16 v[72:75], v[60:63], v[40:43], v[72:75]
  v_mfma_f32_16x16x32_bf16 v[76:79], v[60:63], v[44:47], v[76:79]
  v_mfma_f32_16x16x32_bf16 v[80:83], v[64:67], v[40:43], v[80:83]
  v_mfma_f32_16x16x32_bf16 v[84:87], v[64:67], v[44:47], v[84:87]
  ds_read_b128 v[40:43], v17 offset:0
  ds_read_b128 v[44:47], v17 offset:4096
  ds_read_b64_tr_b16 v[60:61], v18 offset:15456
  ds_read_b64_tr_b16 v[62:63], v19 offset:15456
  ds_read_b64_tr_b16 v[64:65], v18 offset:15488
  ds_read_b64_tr_b16 v[66:67], v19 offset:15488
  s_waitcnt lgkmcnt(6)
  v_mfma_f32_16x16x32_bf16 v[72:75], v[48:51], v[32:35], v[72:75]
  v_mfma_f32_16x16x32_bf16 v[76:79], v[48:51], v[36:39], v[76:79]
  v_mfma_f32_16x16x32_bf16 v[80:83], v[52:55], v[32:35], v[80:83]
  v_mfma_f32_16x16x32_bf16 v[84:87], v[52:55], v[36:39], v[84:87]
  s_waitcnt lgkmcnt(0)
  v_mfma_f32_16x16x32_bf16 v[72:75], v[60:63], v[40:43], v[72:75]
  v_mfma_f32_16x16x32_bf16 v[76:79], v[60:63], v[44:47], v[76:79]
  v_mfma_f32_16x16x32_bf16 v[80:83], v[64:67], v[40:43], v[80:83]
  v_mfma_f32_16x16x32_bf16 v[84:87], v[64:67], v[44:47], v[84:87]
  s_cmp_eq_u32 s56, 1
  s_cbranch_scc0 L_k3_wo_kernel_7
  buffer_load_dwordx2 v[116:117], v128, s[12:15], s35 offen offset:0
  buffer_load_dwordx2 v[118:119], v128, s[12:15], s36 offen offset:0
  buffer_load_dwordx2 v[120:121], v128, s[12:15], s35 offen offset:32
  buffer_load_dwordx2 v[122:123], v128, s[12:15], s36 offen offset:32
L_k3_wo_kernel_7:
  s_add_u32 s56, s56, 1
  s_and_b32 s33, s56, 3
  s_cmp_eq_u32 s33, 0
  s_cselect_b32 s57, -110592, s59
  s_cmp_lt_u32 s56, 5
  s_cbranch_scc1 L_k3_wo_kernel_6
  s_waitcnt vmcnt(0)
  s_nop 7
  s_nop 7
  v_lshlrev_b32 v22, 16, v116
  v_and_b32 v23, 0xffff0000, v116
  v_lshlrev_b32 v24, 16, v117
  v_and_b32 v25, 0xffff0000, v117
  v_add_f32 v72, v72, v22
  v_add_f32 v73, v73, v23
  v_add_f32 v74, v74, v24
  v_add_f32 v75, v75, v25
  v_cvt_pk_bf16_f32 v72, v72, v73
  v_cvt_pk_bf16_f32 v73, v74, v75
  buffer_store_dwordx2 v[72:73], v128, s[16:19], s35 offen offset:0
  v_lshlrev_b32 v22, 16, v118
  v_and_b32 v23, 0xffff0000, v118
  v_lshlrev_b32 v24, 16, v119
  v_and_b32 v25, 0xffff0000, v119
  v_add_f32 v76, v76, v22
  v_add_f32 v77, v77, v23
  v_add_f32 v78, v78, v24
  v_add_f32 v79, v79, v25
  v_cvt_pk_bf16_f32 v76, v76, v77
  v_cvt_pk_bf16_f32 v77, v78, v79
  buffer_store_dwordx2 v[76:77], v128, s[16:19], s36 offen offset:0
  v_lshlrev_b32 v22, 16, v120
  v_and_b32 v23, 0xffff0000, v120
  v_lshlrev_b32 v24, 16, v121
  v_and_b32 v25, 0xffff0000, v121
  v_add_f32 v80, v80, v22
  v_add_f32 v81, v81, v23
  v_add_f32 v82, v82, v24
  v_add_f32 v83, v83, v25
  v_cvt_pk_bf16_f32 v80, v80, v81
  v_cvt_pk_bf16_f32 v81, v82, v83
  buffer_store_dwordx2 v[80:81], v128, s[16:19], s35 offen offset:32
  v_lshlrev_b32 v22, 16, v122
  v_and_b32 v23, 0xffff0000, v122
  v_lshlrev_b32 v24, 16, v123
  v_and_b32 v25, 0xffff0000, v123
  v_add_f32 v84, v84, v22
  v_add_f32 v85, v85, v23
  v_add_f32 v86, v86, v24
  v_add_f32 v87, v87, v25
  v_cvt_pk_bf16_f32 v84, v84, v85
  v_cvt_pk_bf16_f32 v85, v86, v87
  buffer_store_dwordx2 v[84:85], v128, s[16:19], s36 offen offset:32
  s_endpgm
L_k3_wo_kernel_1:
  s_lshl_b32 s33, s25, 6
  s_mul_i32 s33, s33, 1280
  v_add_u32 v22, 0, v2
  v_xor_b32 v23, v22, v3
  v_lshlrev_b32 v23, 4, v23
  v_mul_u32_u24 v22, 1280, v22
  v_add3_u32 v4, v22, v23, s33
  v_add_u32 v22, 4, v2
  v_xor_b32 v23, v22, v3
  v_lshlrev_b32 v23, 4, v23
  v_mul_u32_u24 v22, 1280, v22
  v_add3_u32 v5, v22, v23, s33
  v_add_u32 v22, 8, v2
  v_xor_b32 v23, v22, v3
  v_lshlrev_b32 v23, 4, v23
  v_mul_u32_u24 v22, 1280, v22
  v_add3_u32 v6, v22, v23, s33
  v_add_u32 v22, 12, v2
  v_xor_b32 v23, v22, v3
  v_lshlrev_b32 v23, 4, v23
  v_mul_u32_u24 v22, 1280, v22
  v_add3_u32 v7, v22, v23, s33
  s_waitcnt lgkmcnt(0)
  s_add_u32 s4, s44, 0x300000
  s_addc_u32 s5, s45, 0
  s_mov_b32 s6, 0x280000
  s_mov_b32 s7, 0x20000
  s_add_u32 s8, s44, 0x1100000
  s_addc_u32 s9, s45, 0
  s_mov_b32 s10, 0xc8000
  s_mov_b32 s11, 0x20000
  s_mov_b32 s12, s40
  s_mov_b32 s13, s41
  s_mov_b32 s14, 0x280000
  s_mov_b32 s15, 0x20000
  s_add_u32 s16, s44, 0x600000
  s_addc_u32 s17, s45, 0
  s_mov_b32 s18, 0x280000
  s_mov_b32 s19, 0x20000
  s_setprio 3
  s_mov_b32 s27, 0
  s_mov_b32 s28, 0
  s_mov_b32 s29, 0
  s_mov_b32 s55, 0
  s_mov_b32 s56, 0
L_k3_wo_kernel_8:
  s_cmp_lt_u32 s56, 3
  s_cbranch_scc1 L_k3_wo_kernel_9
  s_waitcnt vmcnt(32)
  s_barrier
L_k3_wo_kernel_9:
  s_add_u32 m0, s55, 0
  s_add_u32 s33, s27, 0
  buffer_load_dwordx4 v4, s[4:7], s33 offen lds
  s_add_u32 m0, s55, 1024
  s_add_u32 s33, s27, 0
  buffer_load_dwordx4 v5, s[4:7], s33 offen lds
  s_add_u32 m0, s55, 2048
  s_add_u32 s33, s27, 0
  buffer_load_dwordx4 v6, s[4:7], s33 offen lds
  s_add_u32 m0, s55, 3072
  s_add_u32 s33, s27, 0
  buffer_load_dwordx4 v7, s[4:7], s33 offen lds
  s_add_u32 m0, s55, 4096
  s_add_u32 s33, s27, 20480
  buffer_load_dwordx4 v4, s[4:7], s33 offen lds
  s_add_u32 m0, s55, 5120
  s_add_u32 s33, s27, 20480
  buffer_load_dwordx4 v5, s[4:7], s33 offen lds
  s_add_u32 m0, s55, 6144
  s_add_u32 s33, s27, 20480
  buffer_load_dwordx4 v6, s[4:7], s33 offen lds
  s_add_u32 m0, s55, 7168
  s_add_u32 s33, s27, 20480
  buffer_load_dwordx4 v7, s[4:7], s33 offen lds
  s_add_u32 m0, s55, 8192
  s_add_u32 s33, s27, 40960
  buffer_load_dwordx4 v4, s[4:7], s33 offen lds
  s_add_u32 m0, s55, 9216
  s_add_u32 s33, s27, 40960
  buffer_load_dwordx4 v5, s[4:7], s33 offen lds
  s_add_u32 m0, s55, 10240
  s_add_u32 s33, s27, 40960
  buffer_load_dwordx4 v6, s[4:7], s33 offen lds
  s_add_u32 m0, s55, 11264
  s_add_u32 s33, s27, 40960
  buffer_load_dwordx4 v7, s[4:7], s33 offen lds
  s_add_u32 m0, s55, 12288
  s_add_u32 s33, s27, 61440
  buffer_load_dwordx4 v4, s[4:7], s33 offen lds
  s_add_u32 m0, s55, 13312
  s_add_u32 s33, s27, 61440
  buffer_load_dwordx4 v5, s[4:7], s33 offen lds
  s_add_u32 m0, s55, 14336
  s_add_u32 s33, s27, 61440
  buffer_load_dwordx4 v6, s[4:7], s33 offen lds
  s_add_u32 m0, s55, 15360
  s_add_u32 s33, s27, 61440
  buffer_load_dwordx4 v7, s[4:7], s33 offen lds
  s_add_u32 s27, s27, 256
  s_add_u32 s55, s55, 36864
  s_cmp_eq_u32 s55, 147456
  s_cselect_b32 s55, 0, s55
  s_add_u32 s56, s56, 1
  s_cmp_lt_u32 s56, 5
  s_cbranch_scc1 L_k3_wo_kernel_8
  s_waitcnt vmcnt(32)
  s_barrier
  s_waitcnt vmcnt(16)
  s_barrier
  s_waitcnt vmcnt(0)
  s_barrier
  s_endpgm
L_k3_wo_kernel_2:
  s_mul_i32 s33, s26, 102400
  v_lshlrev_b32 v22, 4, v1
  v_add_u32 v8, s33, v22
  v_add_u32 v9, 1024, v8
  v_add_u32 v10, 2048, v8
  v_add_u32 v11, 3072, v8
  v_add_u32 v12, 4096, v8
  s_waitcnt lgkmcnt(0)
  s_add_u32 s4, s44, 0x300000
  s_addc_u32 s5, s45, 0
  s_mov_b32 s6, 0x280000
  s_mov_b32 s7, 0x20000
  s_add_u32 s8, s44, 0x1100000
  s_addc_u32 s9, s45, 0
  s_mov_b32 s10, 0xc8000
  s_mov_b32 s11, 0x20000
  s_mov_b32 s12, s40
  s_mov_b32 s13, s41
  s_mov_b32 s14, 0x280000
  s_mov_b32 s15, 0x20000
  s_add_u32 s16, s44, 0x600000
  s_addc_u32 s17, s45, 0
  s_mov_b32 s18, 0x280000
  s_mov_b32 s19, 0x20000
  s_setprio 3
  s_mov_b32 s27, 0
  s_mov_b32 s28, 0
  s_mov_b32 s29, 0
  s_mov_b32 s55, 0
  s_mov_b32 s56, 0
L_k3_wo_kernel_11:
  s_cmp_lt_u32 s56, 3
  s_cbranch_scc1 L_k3_wo_kernel_12
  s_waitcnt vmcnt(40)
  s_barrier
L_k3_wo_kernel_12:
  s_add_u32 m0, s55, 16384
  s_add_u32 s33, s28, 0
  buffer_load_dwordx4 v8, s[8:11], s33 offen lds
  s_add_u32 m0, s55, 17408
  s_add_u32 s33, s28, 0
  buffer_load_dwordx4 v9, s[8:11], s33 offen lds
  s_add_u32 m0, s55, 18432
  s_add_u32 s33, s28, 0
  buffer_load_dwordx4 v10, s[8:11], s33 offen lds
  s_add_u32 m0, s55, 19456
  s_add_u32 s33, s28, 0
  buffer_load_dwordx4 v11, s[8:11], s33 offen lds
  s_add_u32 m0, s55, 20480
  s_add_u32 s33, s28, 0
  buffer_load_dwordx4 v12, s[8:11], s33 offen lds
  s_add_u32 m0, s55, 21504
  s_add_u32 s33, s28, 5120
  buffer_load_dwordx4 v8, s[8:11], s33 offen lds
  s_add_u32 m0, s55, 22528
  s_add_u32 s33, s28, 5120
  buffer_load_dwordx4 v9, s[8:11], s33 offen lds
  s_add_u32 m0, s55, 23552
  s_add_u32 s33, s28, 5120
  buffer_load_dwordx4 v10, s[8:11], s33 offen lds
  s_add_u32 m0, s55, 24576
  s_add_u32 s33, s28, 5120
  buffer_load_dwordx4 v11, s[8:11], s33 offen lds
  s_add_u32 m0, s55, 25600
  s_add_u32 s33, s28, 5120
  buffer_load_dwordx4 v12, s[8:11], s33 offen lds
  s_add_u32 m0, s55, 26624
  s_add_u32 s33, s28, 10240
  buffer_load_dwordx4 v8, s[8:11], s33 offen lds
  s_add_u32 m0, s55, 27648
  s_add_u32 s33, s28, 10240
  buffer_load_dwordx4 v9, s[8:11], s33 offen lds
  s_add_u32 m0, s55, 28672
  s_add_u32 s33, s28, 10240
  buffer_load_dwordx4 v10, s[8:11], s33 offen lds
  s_add_u32 m0, s55, 29696
  s_add_u32 s33, s28, 10240
  buffer_load_dwordx4 v11, s[8:11], s33 offen lds
  s_add_u32 m0, s55, 30720
  s_add_u32 s33, s28, 10240
  buffer_load_dwordx4 v12, s[8:11], s33 offen lds
  s_add_u32 m0, s55, 31744
  s_add_u32 s33, s28, 15360
  buffer_load_dwordx4 v8, s[8:11], s33 offen lds
  s_add_u32 m0, s55, 32768
  s_add_u32 s33, s28, 15360
  buffer_load_dwordx4 v9, s[8:11], s33 offen lds
  s_add_u32 m0, s55, 33792
  s_add_u32 s33, s28, 15360
  buffer_load_dwordx4 v10, s[8:11], s33 offen lds
  s_add_u32 m0, s55, 34816
  s_add_u32 s33, s28, 15360
  buffer_load_dwordx4 v11, s[8:11], s33 offen lds
  s_add_u32 m0, s55, 35840
  s_add_u32 s33, s28, 15360
  buffer_load_dwordx4 v12, s[8:11], s33 offen lds
  s_add_u32 s28, s28, 20480
  s_add_u32 s55, s55, 36864
  s_cmp_eq_u32 s55, 147456
  s_cselect_b32 s55, 0, s55
  s_add_u32 s56, s56, 1
  s_cmp_lt_u32 s56, 5
  s_cbranch_scc1 L_k3_wo_kernel_11
  s_waitcnt vmcnt(40)
  s_barrier
  s_waitcnt vmcnt(20)
  s_barrier
  s_waitcnt vmcnt(0)
  s_barrier
  s_endpgm
L_k3_wo_kernel_end:
  s_endpgm
.globl k4_gateup_kernel
.p2align 8
.type k4_gateup_kernel,@function
k4_gateup_kernel:
  s_cmp_ge_u32 s2, 256
  s_cbranch_scc1 L_k4_gateup_kernel_end
  s_load_dwordx2 s[40:41], s[0:1], 88
  v_and_b32 v1, 63, v0
  v_lshrrev_b32 v16, 6, v0
  v_lshrrev_b32 v2, 4, v1
  v_readfirstlane_b32 s24, v16
  v_and_b32 v3, 15, v1
  s_lshr_b32 s33, s2, 3
  s_bfe_u32 s25, s2, 0x10002
  s_lshl_b32 s25, s25, 3
  s_lshr_b32 s34, s33, 2
  s_add_u32 s25, s25, s34
  s_and_b32 s26, s2, 3
  s_lshl_b32 s26, s26, 2
  s_and_b32 s33, s33, 3
  s_add_u32 s26, s26, s33
  s_cmp_eq_u32 s24, 8
  s_cbranch_scc1 L_k4_gateup_kernel_1
  s_cmp_eq_u32 s24, 9
  s_cbranch_scc1 L_k4_gateup_kernel_2
  s_waitcnt lgkmcnt(0)
  s_add_u32 s4, s40, 0x600000
  s_addc_u32 s5, s41, 0
  s_mov_b32 s6, 0x280000
  s_mov_b32 s7, 0x20000
  s_add_u32 s8, s40, 0x1500000
  s_addc_u32 s9, s41, 0
  s_mov_b32 s10, 0x460000
  s_mov_b32 s11, 0x20000
  s_add_u32 s16, s40, 0x900000
  s_addc_u32 s17, s41, 0
  s_mov_b32 s18, 0x6c0000
  s_mov_b32 s19, 0x20000
  s_add_u32 s20, s40, 0x1000000
  s_addc_u32 s21, s41, 0
  s_mov_b32 s22, 0x3600
  s_mov_b32 s23, 0x20000
  s_and_b32 s33, s24, 3
  s_lshl_b32 s33, s33, 12
  v_and_b32 v16, 7, v3
  v_xor_b32 v16, v16, v2
  v_lshlrev_b32 v17, 7, v3
  v_add_u32 v17, s33, v17
  v_lshl_add_u32 v11, v16, 4, v17
  v_xor_b32 v16, 4, v16
  v_lshl_add_u32 v12, v16, 4, v17
  v_lshrrev_b32 v16, 2, v1
  v_and_b32 v16, 3, v16
  v_and_b32 v17, 1, v2
  v_lshlrev_b32 v17, 2, v17
  v_xor_b32 v16, v16, v17
  v_lshl_add_u32 v16, v2, 3, v16
  v_xor_b32 v17, 4, v16
  v_and_b32 v18, 3, v1
  v_lshlrev_b32 v18, 3, v18
  v_add_u32 v18, 16384, v18
  v_mul_u32_u24 v13, 224, v16
  v_mul_u32_u24 v14, 224, v17
  v_add_u32 v13, v13, v18
  v_add_u32 v14, v14, v18
  s_lshl_b32 s33, s25, 7
  s_and_b32 s34, s24, 3
  s_lshl_b32 s34, s34, 5
  s_add_u32 s33, s33, s34
  v_add_u32 v16, s33, v3
  v_mul_u32_u24 v28, 3456, v16
  s_mul_i32 s33, s26, 224
  s_lshr_b32 s34, s24, 2
  s_lshl_b32 s34, s34, 7
  s_add_u32 s33, s33, s34
  v_lshlrev_b32 v16, 3, v2
  v_add3_u32 v28, v28, v16, s33
  v_mov_b32 v33, 0x3f803f80
  v_mov_b32 v100, 0
  v_mov_b32 v101, 0
  v_mov_b32 v102, 0
  v_mov_b32 v103, 0
  v_mov_b32 v104, 0
  v_mov_b32 v105, 0
  v_mov_b32 v106, 0
  v_mov_b32 v107, 0
  v_mov_b32 v108, 0
  v_mov_b32 v109, 0
  v_mov_b32 v110, 0
  v_mov_b32 v111, 0
  v_mov_b32 v112, 0
  v_mov_b32 v113, 0
  v_mov_b32 v114, 0
  v_mov_b32 v115, 0
  v_mov_b32 v116, 0
  v_mov_b32 v117, 0
  v_mov_b32 v118, 0
  v_mov_b32 v119, 0
  v_mov_b32 v120, 0
  v_mov_b32 v121, 0
  v_mov_b32 v122, 0
  v_mov_b32 v123, 0
  v_mov_b32 v124, 0
  v_mov_b32 v125, 0
  v_mov_b32 v126, 0
  v_mov_b32 v127, 0
  v_mov_b32 v128, 0
  v_mov_b32 v129, 0
  v_mov_b32 v130, 0
  v_mov_b32 v131, 0
  v_mov_b32 v132, 0
  v_mov_b32 v133, 0
  v_mov_b32 v134, 0
  v_mov_b32 v135, 0
  v_mov_b32 v136, 0
  v_mov_b32 v137, 0
  v_mov_b32 v138, 0
  v_mov_b32 v139, 0
  v_mov_b32 v140, 0
  v_mov_b32 v141, 0
  v_mov_b32 v142, 0
  v_mov_b32 v143, 0
  v_mov_b32 v144, 0
  v_mov_b32 v145, 0
  v_mov_b32 v146, 0
  v_mov_b32 v147, 0
  v_mov_b32 v148, 0
  v_mov_b32 v149, 0
  v_mov_b32 v150, 0
  v_mov_b32 v151, 0
  v_mov_b32 v152, 0
  v_mov_b32 v153, 0
  v_mov_b32 v154, 0
  v_mov_b32 v155, 0
  v_mov_b32 v156, 0
  v_mov_b32 v157, 0
  v_mov_b32 v158, 0
  v_mov_b32 v159, 0
  v_mov_b32 v160, 0
  v_mov_b32 v161, 0
  v_mov_b32 v162, 0
  v_mov_b32 v163, 0
  v_mov_b32 v29, 0
  v_mov_b32 v30, 0
  v_mov_b32 v31, 0
  v_mov_b32 v32, 0
  s_cmp_ge_u32 s24, 4
  s_cbranch_scc1 L_k4_gateup_kernel_3
  s_mov_b32 s48, 0
  s_mov_b32 s49, 0
  s_mov_b32 s50, 45056
  s_mov_b32 s51, 0
  s_barrier
  ds_read_b128 v[36:39], v11 offset:0
  ds_read_b128 v[40:43], v11 offset:2048
  ds_read_b64_tr_b16 v[52:53], v13 offset:0
  ds_read_b64_tr_b16 v[54:55], v14 offset:0
  ds_read_b64_tr_b16 v[56:57], v13 offset:14336
  ds_read_b64_tr_b16 v[58:59], v14 offset:14336
  ds_read_b64_tr_b16 v[60:61], v13 offset:32
  ds_read_b64_tr_b16 v[62:63], v14 offset:32
  ds_read_b64_tr_b16 v[64:65], v13 offset:14368
  ds_read_b64_tr_b16 v[66:67], v14 offset:14368
  ds_read_b64_tr_b16 v[68:69], v13 offset:64
  ds_read_b64_tr_b16 v[70:71], v14 offset:64
  ds_read_b64_tr_b16 v[72:73], v13 offset:14400
  ds_read_b64_tr_b16 v[74:75], v14 offset:14400
  ds_read_b64_tr_b16 v[76:77], v13 offset:96
  ds_read_b64_tr_b16 v[78:79], v14 offset:96
  ds_read_b64_tr_b16 v[80:81], v13 offset:14432
  ds_read_b64_tr_b16 v[82:83], v14 offset:14432
  s_mov_b32 s49, s50
  s_mov_b32 s51, 1
L_k4_gateup_kernel_4:
  s_waitcnt lgkmcnt(8)
  v_mfma_f32_16x16x32_bf16 v[100:103], v[52:55], v[36:39], v[100:103]
  v_mfma_f32_16x16x32_bf16 v[104:107], v[52:55], v[40:43], v[104:107]
  v_mfma_f32_16x16x32_bf16 v[108:111], v[56:59], v[36:39], v[108:111]
  v_mfma_f32_16x16x32_bf16 v[112:115], v[56:59], v[40:43], v[112:115]
  v_mfma_f32_16x16x32_bf16 v[116:119], v[60:63], v[36:39], v[116:119]
  v_mfma_f32_16x16x32_bf16 v[120:123], v[60:63], v[40:43], v[120:123]
  v_mfma_f32_16x16x32_bf16 v[124:127], v[64:67], v[36:39], v[124:127]
  v_mfma_f32_16x16x32_bf16 v[128:131], v[64:67], v[40:43], v[128:131]
  s_waitcnt lgkmcnt(0)
  ds_read_b128 v[44:47], v12 offset:0
  ds_read_b128 v[48:51], v12 offset:2048
  ds_read_b64_tr_b16 v[52:53], v13 offset:7168
  ds_read_b64_tr_b16 v[54:55], v14 offset:7168
  ds_read_b64_tr_b16 v[56:57], v13 offset:21504
  ds_read_b64_tr_b16 v[58:59], v14 offset:21504
  ds_read_b64_tr_b16 v[60:61], v13 offset:7200
  ds_read_b64_tr_b16 v[62:63], v14 offset:7200
  ds_read_b64_tr_b16 v[64:65], v13 offset:21536
  ds_read_b64_tr_b16 v[66:67], v14 offset:21536
  ds_read_b64_tr_b16 v[84:85], v13 offset:7232
  ds_read_b64_tr_b16 v[86:87], v14 offset:7232
  ds_read_b64_tr_b16 v[88:89], v13 offset:21568
  ds_read_b64_tr_b16 v[90:91], v14 offset:21568
  ds_read_b64_tr_b16 v[92:93], v13 offset:7264
  ds_read_b64_tr_b16 v[94:95], v14 offset:7264
  ds_read_b64_tr_b16 v[96:97], v13 offset:21600
  ds_read_b64_tr_b16 v[98:99], v14 offset:21600
  v_mfma_f32_16x16x32_bf16 v[132:135], v[68:71], v[36:39], v[132:135]
  v_mfma_f32_16x16x32_bf16 v[136:139], v[68:71], v[40:43], v[136:139]
  v_mfma_f32_16x16x32_bf16 v[140:143], v[72:75], v[36:39], v[140:143]
  v_mfma_f32_16x16x32_bf16 v[144:147], v[72:75], v[40:43], v[144:147]
  v_mfma_f32_16x16x32_bf16 v[148:151], v[76:79], v[36:39], v[148:151]
  v_mfma_f32_16x16x32_bf16 v[152:155], v[76:79], v[40:43], v[152:155]
  v_mfma_f32_16x16x32_bf16 v[156:159], v[80:83], v[36:39], v[156:159]
  v_mfma_f32_16x16x32_bf16 v[160:163], v[80:83], v[40:43], v[160:163]
  s_waitcnt lgkmcnt(0)
  s_barrier
  v_mfma_f32_16x16x32_bf16 v[100:103], v[52:55], v[44:47], v[100:103]
  v_mfma_f32_16x16x32_bf16 v[104:107], v[52:55], v[48:51], v[104:107]
  v_mfma_f32_16x16x32_bf16 v[108:111], v[56:59], v[44:47], v[108:111]
  v_mfma_f32_16x16x32_bf16 v[112:115], v[56:59], v[48:51], v[112:115]
  v_mfma_f32_16x16x32_bf16 v[116:119], v[60:63], v[44:47], v[116:119]
  v_mfma_f32_16x16x32_bf16 v[120:123], v[60:63], v[48:51], v[120:123]
  v_mfma_f32_16x16x32_bf16 v[124:127], v[64:67], v[44:47], v[124:127]
  v_mfma_f32_16x16x32_bf16 v[128:131], v[64:67], v[48:51], v[128:131]
  v_add_u32 v11, s49, v11
  v_add_u32 v12, s49, v12
  v_add_u32 v13, s49, v13
  v_add_u32 v14, s49, v14
  ds_read_b128 v[36:39], v11 offset:0
  ds_read_b128 v[40:43], v11 offset:2048
  ds_read_b64_tr_b16 v[52:53], v13 offset:0
  ds_read_b64_tr_b16 v[54:55], v14 offset:0
  ds_read_b64_tr_b16 v[56:57], v13 offset:14336
  ds_read_b64_tr_b16 v[58:59], v14 offset:14336
  ds_read_b64_tr_b16 v[60:61], v13 offset:32
  ds_read_b64_tr_b16 v[62:63], v14 offset:32
  ds_read_b64_tr_b16 v[64:65], v13 offset:14368
  ds_read_b64_tr_b16 v[66:67], v14 offset:14368
  ds_read_b64_tr_b16 v[68:69], v13 offset:64
  ds_read_b64_tr_b16 v[70:71], v14 offset:64
  ds_read_b64_tr_b16 v[72:73], v13 offset:14400
  ds_read_b64_tr_b16 v[74:75], v14 offset:14400
  ds_read_b64_tr_b16 v[76:77], v13 offset:96
  ds_read_b64_tr_b16 v[78:79], v14 offset:96
  ds_read_b64_tr_b16 v[80:81], v13 offset:14432
  ds_read_b64_tr_b16 v[82:83], v14 offset:14432
  v_mfma_f32_16x16x32_bf16 v[132:135], v[84:87], v[44:47], v[132:135]
  v_mfma_f32_16x16x32_bf16 v[136:139], v[84:87], v[48:51], v[136:139]
  v_mfma_f32_16x16x32_bf16 v[140:143], v[88:91], v[44:47], v[140:143]
  v_mfma_f32_16x16x32_bf16 v[144:147], v[88:91], v[48:51], v[144:147]
  v_mfma_f32_16x16x32_bf16 v[148:151], v[92:95], v[44:47], v[148:151]
  v_mfma_f32_16x16x32_bf16 v[152:155], v[92:95], v[48:51], v[152:155]
  v_mfma_f32_16x16x32_bf16 v[156:159], v[96:99], v[44:47], v[156:159]
  v_mfma_f32_16x16x32_bf16 v[160:163], v[96:99], v[48:51], v[160:163]
  s_add_u32 s48, s48, 1
  s_add_u32 s51, s51, 1
  s_cmp_eq_u32 s51, 3
  s_cselect_b32 s49, -90112, s50
  s_cselect_b32 s51, 0, s51
  s_cmp_lt_u32 s48, 10
  s_cbranch_scc1 L_k4_gateup_kernel_4
  s_waitcnt lgkmcnt(0)
  s_nop 7
  s_nop 7
  v_lshlrev_b32 v26, 4, v2
  v_add_u32 v26, 135168, v26
  ds_read_b128 v[52:55], v26 offset:0
  ds_read_b128 v[56:59], v26 offset:448
  ds_read_b128 v[60:63], v26 offset:64
  ds_read_b128 v[64:67], v26 offset:512
  ds_read_b128 v[68:71], v26 offset:128
  ds_read_b128 v[72:75], v26 offset:576
  ds_read_b128 v[76:79], v26 offset:192
  ds_read_b128 v[80:83], v26 offset:640
  s_and_b32 s33, s24, 3
  s_lshl_b32 s33, s33, 8
  v_lshlrev_b32 v20, 3, v3
  v_add_u32 v20, s33, v20
  s_barrier
  s_barrier
  ds_read_b64 v[22:23], v20
  ds_read_b64 v[24:25], v20 offset:128
  s_waitcnt lgkmcnt(0)
  v_mul_f32 v23, v23, v23
  v_mul_f32 v25, v25, v25
  s_mov_b32 s33, 55296
  s_mul_i32 s34, s26, 112
  v_lshl_add_u32 v27, v2, 3, v28
  s_cmp_gt_u32 s34, 1712
  s_cbranch_scc1 L_k4_gateup_kernel_5
  s_cmp_gt_u32 s34, 1696
  s_cbranch_scc1 L_k4_gateup_kernel_6
  v_fma_f32 v116, -v22, v60, v116
  v_fma_f32 v124, -v22, v64, v124
  v_mul_f32 v116, v116, v23
  v_mul_f32 v116, v116, v124
  v_fma_f32 v117, -v22, v61, v117
  v_fma_f32 v125, -v22, v65, v125
  v_mul_f32 v117, v117, v23
  v_mul_f32 v117, v117, v125
  v_fma_f32 v118, -v22, v62, v118
  v_fma_f32 v126, -v22, v66, v126
  v_mul_f32 v118, v118, v23
  v_mul_f32 v118, v118, v126
  v_fma_f32 v119, -v22, v63, v119
  v_fma_f32 v127, -v22, v67, v127
  v_mul_f32 v119, v119, v23
  v_mul_f32 v119, v119, v127
  v_cvt_pk_bf16_f32 v38, v116, v117
  v_cvt_pk_bf16_f32 v39, v118, v119
  v_fma_f32 v100, -v22, v52, v100
  v_fma_f32 v108, -v22, v56, v108
  v_mul_f32 v100, v100, v23
  v_mul_f32 v100, v100, v108
  v_fma_f32 v101, -v22, v53, v101
  v_fma_f32 v109, -v22, v57, v109
  v_mul_f32 v101, v101, v23
  v_mul_f32 v101, v101, v109
  v_fma_f32 v102, -v22, v54, v102
  v_fma_f32 v110, -v22, v58, v110
  v_mul_f32 v102, v102, v23
  v_mul_f32 v102, v102, v110
  v_fma_f32 v103, -v22, v55, v103
  v_fma_f32 v111, -v22, v59, v111
  v_mul_f32 v103, v103, v23
  v_mul_f32 v103, v103, v111
  v_cvt_pk_bf16_f32 v36, v100, v101
  v_cvt_pk_bf16_f32 v37, v102, v103
  s_nop 1
  v_permlane32_swap_b32 v36, v38
  v_permlane32_swap_b32 v37, v39
  s_nop 1
  v_permlane16_swap_b32 v36, v38
  v_permlane16_swap_b32 v37, v39
  s_nop 1
  buffer_store_dwordx4 v[36:39], v27, s[16:19], 0 offen offset:0
  v_fma_f32 v120, -v24, v60, v120
  v_fma_f32 v128, -v24, v64, v128
  v_mul_f32 v120, v120, v25
  v_mul_f32 v120, v120, v128
  v_fma_f32 v121, -v24, v61, v121
  v_fma_f32 v129, -v24, v65, v129
  v_mul_f32 v121, v121, v25
  v_mul_f32 v121, v121, v129
  v_fma_f32 v122, -v24, v62, v122
  v_fma_f32 v130, -v24, v66, v130
  v_mul_f32 v122, v122, v25
  v_mul_f32 v122, v122, v130
  v_fma_f32 v123, -v24, v63, v123
  v_fma_f32 v131, -v24, v67, v131
  v_mul_f32 v123, v123, v25
  v_mul_f32 v123, v123, v131
  v_cvt_pk_bf16_f32 v42, v120, v121
  v_cvt_pk_bf16_f32 v43, v122, v123
  v_fma_f32 v104, -v24, v52, v104
  v_fma_f32 v112, -v24, v56, v112
  v_mul_f32 v104, v104, v25
  v_mul_f32 v104, v104, v112
  v_fma_f32 v105, -v24, v53, v105
  v_fma_f32 v113, -v24, v57, v113
  v_mul_f32 v105, v105, v25
  v_mul_f32 v105, v105, v113
  v_fma_f32 v106, -v24, v54, v106
  v_fma_f32 v114, -v24, v58, v114
  v_mul_f32 v106, v106, v25
  v_mul_f32 v106, v106, v114
  v_fma_f32 v107, -v24, v55, v107
  v_fma_f32 v115, -v24, v59, v115
  v_mul_f32 v107, v107, v25
  v_mul_f32 v107, v107, v115
  v_cvt_pk_bf16_f32 v40, v104, v105
  v_cvt_pk_bf16_f32 v41, v106, v107
  s_nop 1
  v_permlane32_swap_b32 v40, v42
  v_permlane32_swap_b32 v41, v43
  s_nop 1
  v_permlane16_swap_b32 v40, v42
  v_permlane16_swap_b32 v41, v43
  s_nop 1
  buffer_store_dwordx4 v[40:43], v27, s[16:19], s33 offen offset:0
  s_branch L_k4_gateup_kernel_7
L_k4_gateup_kernel_6:
  v_fma_f32 v100, -v22, v52, v100
  v_fma_f32 v108, -v22, v56, v108
  v_mul_f32 v100, v100, v23
  v_mul_f32 v100, v100, v108
  v_fma_f32 v101, -v22, v53, v101
  v_fma_f32 v109, -v22, v57, v109
  v_mul_f32 v101, v101, v23
  v_mul_f32 v101, v101, v109
  v_fma_f32 v102, -v22, v54, v102
  v_fma_f32 v110, -v22, v58, v110
  v_mul_f32 v102, v102, v23
  v_mul_f32 v102, v102, v110
  v_fma_f32 v103, -v22, v55, v103
  v_fma_f32 v111, -v22, v59, v111
  v_mul_f32 v103, v103, v23
  v_mul_f32 v103, v103, v111
  v_cvt_pk_bf16_f32 v44, v100, v101
  v_cvt_pk_bf16_f32 v45, v102, v103
  buffer_store_dwordx2 v[44:45], v28, s[16:19], 0 offen offset:0
  v_fma_f32 v104, -v24, v52, v104
  v_fma_f32 v112, -v24, v56, v112
  v_mul_f32 v104, v104, v25
  v_mul_f32 v104, v104, v112
  v_fma_f32 v105, -v24, v53, v105
  v_fma_f32 v113, -v24, v57, v113
  v_mul_f32 v105, v105, v25
  v_mul_f32 v105, v105, v113
  v_fma_f32 v106, -v24, v54, v106
  v_fma_f32 v114, -v24, v58, v114
  v_mul_f32 v106, v106, v25
  v_mul_f32 v106, v106, v114
  v_fma_f32 v107, -v24, v55, v107
  v_fma_f32 v115, -v24, v59, v115
  v_mul_f32 v107, v107, v25
  v_mul_f32 v107, v107, v115
  v_cvt_pk_bf16_f32 v46, v104, v105
  v_cvt_pk_bf16_f32 v47, v106, v107
  buffer_store_dwordx2 v[46:47], v28, s[16:19], s33 offen offset:0
  s_branch L_k4_gateup_kernel_5
L_k4_gateup_kernel_7:
  s_cmp_gt_u32 s34, 1680
  s_cbranch_scc1 L_k4_gateup_kernel_5
  s_cmp_gt_u32 s34, 1664
  s_cbranch_scc1 L_k4_gateup_kernel_8
  v_fma_f32 v148, -v22, v76, v148
  v_fma_f32 v156, -v22, v80, v156
  v_mul_f32 v148, v148, v23
  v_mul_f32 v148, v148, v156
  v_fma_f32 v149, -v22, v77, v149
  v_fma_f32 v157, -v22, v81, v157
  v_mul_f32 v149, v149, v23
  v_mul_f32 v149, v149, v157
  v_fma_f32 v150, -v22, v78, v150
  v_fma_f32 v158, -v22, v82, v158
  v_mul_f32 v150, v150, v23
  v_mul_f32 v150, v150, v158
  v_fma_f32 v151, -v22, v79, v151
  v_fma_f32 v159, -v22, v83, v159
  v_mul_f32 v151, v151, v23
  v_mul_f32 v151, v151, v159
  v_cvt_pk_bf16_f32 v38, v148, v149
  v_cvt_pk_bf16_f32 v39, v150, v151
  v_fma_f32 v132, -v22, v68, v132
  v_fma_f32 v140, -v22, v72, v140
  v_mul_f32 v132, v132, v23
  v_mul_f32 v132, v132, v140
  v_fma_f32 v133, -v22, v69, v133
  v_fma_f32 v141, -v22, v73, v141
  v_mul_f32 v133, v133, v23
  v_mul_f32 v133, v133, v141
  v_fma_f32 v134, -v22, v70, v134
  v_fma_f32 v142, -v22, v74, v142
  v_mul_f32 v134, v134, v23
  v_mul_f32 v134, v134, v142
  v_fma_f32 v135, -v22, v71, v135
  v_fma_f32 v143, -v22, v75, v143
  v_mul_f32 v135, v135, v23
  v_mul_f32 v135, v135, v143
  v_cvt_pk_bf16_f32 v36, v132, v133
  v_cvt_pk_bf16_f32 v37, v134, v135
  s_nop 1
  v_permlane32_swap_b32 v36, v38
  v_permlane32_swap_b32 v37, v39
  s_nop 1
  v_permlane16_swap_b32 v36, v38
  v_permlane16_swap_b32 v37, v39
  s_nop 1
  buffer_store_dwordx4 v[36:39], v27, s[16:19], 0 offen offset:64
  v_fma_f32 v152, -v24, v76, v152
  v_fma_f32 v160, -v24, v80, v160
  v_mul_f32 v152, v152, v25
  v_mul_f32 v152, v152, v160
  v_fma_f32 v153, -v24, v77, v153
  v_fma_f32 v161, -v24, v81, v161
  v_mul_f32 v153, v153, v25
  v_mul_f32 v153, v153, v161
  v_fma_f32 v154, -v24, v78, v154
  v_fma_f32 v162, -v24, v82, v162
  v_mul_f32 v154, v154, v25
  v_mul_f32 v154, v154, v162
  v_fma_f32 v155, -v24, v79, v155
  v_fma_f32 v163, -v24, v83, v163
  v_mul_f32 v155, v155, v25
  v_mul_f32 v155, v155, v163
  v_cvt_pk_bf16_f32 v42, v152, v153
  v_cvt_pk_bf16_f32 v43, v154, v155
  v_fma_f32 v136, -v24, v68, v136
  v_fma_f32 v144, -v24, v72, v144
  v_mul_f32 v136, v136, v25
  v_mul_f32 v136, v136, v144
  v_fma_f32 v137, -v24, v69, v137
  v_fma_f32 v145, -v24, v73, v145
  v_mul_f32 v137, v137, v25
  v_mul_f32 v137, v137, v145
  v_fma_f32 v138, -v24, v70, v138
  v_fma_f32 v146, -v24, v74, v146
  v_mul_f32 v138, v138, v25
  v_mul_f32 v138, v138, v146
  v_fma_f32 v139, -v24, v71, v139
  v_fma_f32 v147, -v24, v75, v147
  v_mul_f32 v139, v139, v25
  v_mul_f32 v139, v139, v147
  v_cvt_pk_bf16_f32 v40, v136, v137
  v_cvt_pk_bf16_f32 v41, v138, v139
  s_nop 1
  v_permlane32_swap_b32 v40, v42
  v_permlane32_swap_b32 v41, v43
  s_nop 1
  v_permlane16_swap_b32 v40, v42
  v_permlane16_swap_b32 v41, v43
  s_nop 1
  buffer_store_dwordx4 v[40:43], v27, s[16:19], s33 offen offset:64
  s_branch L_k4_gateup_kernel_9
L_k4_gateup_kernel_8:
  v_fma_f32 v132, -v22, v68, v132
  v_fma_f32 v140, -v22, v72, v140
  v_mul_f32 v132, v132, v23
  v_mul_f32 v132, v132, v140
  v_fma_f32 v133, -v22, v69, v133
  v_fma_f32 v141, -v22, v73, v141
  v_mul_f32 v133, v133, v23
  v_mul_f32 v133, v133, v141
  v_fma_f32 v134, -v22, v70, v134
  v_fma_f32 v142, -v22, v74, v142
  v_mul_f32 v134, v134, v23
  v_mul_f32 v134, v134, v142
  v_fma_f32 v135, -v22, v71, v135
  v_fma_f32 v143, -v22, v75, v143
  v_mul_f32 v135, v135, v23
  v_mul_f32 v135, v135, v143
  v_cvt_pk_bf16_f32 v44, v132, v133
  v_cvt_pk_bf16_f32 v45, v134, v135
  buffer_store_dwordx2 v[44:45], v28, s[16:19], 0 offen offset:64
  v_fma_f32 v136, -v24, v68, v136
  v_fma_f32 v144, -v24, v72, v144
  v_mul_f32 v136, v136, v25
  v_mul_f32 v136, v136, v144
  v_fma_f32 v137, -v24, v69, v137
  v_fma_f32 v145, -v24, v73, v145
  v_mul_f32 v137, v137, v25
  v_mul_f32 v137, v137, v145
  v_fma_f32 v138, -v24, v70, v138
  v_fma_f32 v146, -v24, v74, v146
  v_mul_f32 v138, v138, v25
  v_mul_f32 v138, v138, v146
  v_fma_f32 v139, -v24, v71, v139
  v_fma_f32 v147, -v24, v75, v147
  v_mul_f32 v139, v139, v25
  v_mul_f32 v139, v139, v147
  v_cvt_pk_bf16_f32 v46, v136, v137
  v_cvt_pk_bf16_f32 v47, v138, v139
  buffer_store_dwordx2 v[46:47], v28, s[16:19], s33 offen offset:64
  s_branch L_k4_gateup_kernel_5
L_k4_gateup_kernel_9:
L_k4_gateup_kernel_5:
  s_endpgm
L_k4_gateup_kernel_3:
  s_mov_b32 s48, 0
  s_mov_b32 s49, 0
  s_mov_b32 s50, 45056
  s_mov_b32 s51, 0
  v_mov_b32 v76, 0x3f803f80
  v_mov_b32 v77, 0x3f803f80
  v_mov_b32 v78, 0x3f803f80
  v_mov_b32 v79, 0x3f803f80
  s_barrier
  ds_read_b128 v[36:39], v11 offset:0
  ds_read_b128 v[40:43], v11 offset:2048
  ds_read_b64_tr_b16 v[52:53], v13 offset:128
  ds_read_b64_tr_b16 v[54:55], v14 offset:128
  ds_read_b64_tr_b16 v[56:57], v13 offset:14464
  ds_read_b64_tr_b16 v[58:59], v14 offset:14464
  ds_read_b64_tr_b16 v[60:61], v13 offset:160
  ds_read_b64_tr_b16 v[62:63], v14 offset:160
  ds_read_b64_tr_b16 v[64:65], v13 offset:14496
  ds_read_b64_tr_b16 v[66:67], v14 offset:14496
  ds_read_b64_tr_b16 v[68:69], v13 offset:192
  ds_read_b64_tr_b16 v[70:71], v14 offset:192
  ds_read_b64_tr_b16 v[72:73], v13 offset:14528
  ds_read_b64_tr_b16 v[74:75], v14 offset:14528
  s_mov_b32 s49, s50
  s_mov_b32 s51, 1
L_k4_gateup_kernel_10:
  s_waitcnt lgkmcnt(4)
  v_mfma_f32_16x16x32_bf16 v[100:103], v[52:55], v[36:39], v[100:103]
  v_mfma_f32_16x16x32_bf16 v[104:107], v[52:55], v[40:43], v[104:107]
  v_mfma_f32_16x16x32_bf16 v[108:111], v[56:59], v[36:39], v[108:111]
  v_mfma_f32_16x16x32_bf16 v[112:115], v[56:59], v[40:43], v[112:115]
  v_mfma_f32_16x16x32_bf16 v[116:119], v[60:63], v[36:39], v[116:119]
  v_mfma_f32_16x16x32_bf16 v[120:123], v[60:63], v[40:43], v[120:123]
  v_mfma_f32_16x16x32_bf16 v[124:127], v[64:67], v[36:39], v[124:127]
  v_mfma_f32_16x16x32_bf16 v[128:131], v[64:67], v[40:43], v[128:131]
  s_waitcnt lgkmcnt(0)
  ds_read_b128 v[44:47], v12 offset:0
  ds_read_b128 v[48:51], v12 offset:2048
  ds_read_b64_tr_b16 v[52:53], v13 offset:7296
  ds_read_b64_tr_b16 v[54:55], v14 offset:7296
  ds_read_b64_tr_b16 v[56:57], v13 offset:21632
  ds_read_b64_tr_b16 v[58:59], v14 offset:21632
  ds_read_b64_tr_b16 v[60:61], v13 offset:7328
  ds_read_b64_tr_b16 v[62:63], v14 offset:7328
  ds_read_b64_tr_b16 v[64:65], v13 offset:21664
  ds_read_b64_tr_b16 v[66:67], v14 offset:21664
  ds_read_b64_tr_b16 v[84:85], v13 offset:7360
  ds_read_b64_tr_b16 v[86:87], v14 offset:7360
  ds_read_b64_tr_b16 v[88:89], v13 offset:21696
  ds_read_b64_tr_b16 v[90:91], v14 offset:21696
  v_mfma_f32_16x16x32_bf16 v[132:135], v[68:71], v[36:39], v[132:135]
  v_mfma_f32_16x16x32_bf16 v[136:139], v[68:71], v[40:43], v[136:139]
  v_mfma_f32_16x16x32_bf16 v[140:143], v[72:75], v[36:39], v[140:143]
  v_mfma_f32_16x16x32_bf16 v[144:147], v[72:75], v[40:43], v[144:147]
  v_mfma_f32_16x16x32_bf16 v[148:151], v[76:79], v[36:39], v[148:151]
  v_mfma_f32_16x16x32_bf16 v[156:159], v[36:39], v[36:39], v[156:159]
  v_mfma_f32_16x16x32_bf16 v[152:155], v[76:79], v[40:43], v[152:155]
  v_mfma_f32_16x16x32_bf16 v[160:163], v[40:43], v[40:43], v[160:163]
  s_waitcnt lgkmcnt(0)
  s_barrier
  v_mfma_f32_16x16x32_bf16 v[100:103], v[52:55], v[44:47], v[100:103]
  v_mfma_f32_16x16x32_bf16 v[104:107], v[52:55], v[48:51], v[104:107]
  v_mfma_f32_16x16x32_bf16 v[108:111], v[56:59], v[44:47], v[108:111]
  v_mfma_f32_16x16x32_bf16 v[112:115], v[56:59], v[48:51], v[112:115]
  v_mfma_f32_16x16x32_bf16 v[116:119], v[60:63], v[44:47], v[116:119]
  v_mfma_f32_16x16x32_bf16 v[120:123], v[60:63], v[48:51], v[120:123]
  v_mfma_f32_16x16x32_bf16 v[124:127], v[64:67], v[44:47], v[124:127]
  v_mfma_f32_16x16x32_bf16 v[128:131], v[64:67], v[48:51], v[128:131]
  v_add_u32 v11, s49, v11
  v_add_u32 v12, s49, v12
  v_add_u32 v13, s49, v13
  v_add_u32 v14, s49, v14
  ds_read_b128 v[36:39], v11 offset:0
  ds_read_b128 v[40:43], v11 offset:2048
  ds_read_b64_tr_b16 v[52:53], v13 offset:128
  ds_read_b64_tr_b16 v[54:55], v14 offset:128
  ds_read_b64_tr_b16 v[56:57], v13 offset:14464
  ds_read_b64_tr_b16 v[58:59], v14 offset:14464
  ds_read_b64_tr_b16 v[60:61], v13 offset:160
  ds_read_b64_tr_b16 v[62:63], v14 offset:160
  ds_read_b64_tr_b16 v[64:65], v13 offset:14496
  ds_read_b64_tr_b16 v[66:67], v14 offset:14496
  ds_read_b64_tr_b16 v[68:69], v13 offset:192
  ds_read_b64_tr_b16 v[70:71], v14 offset:192
  ds_read_b64_tr_b16 v[72:73], v13 offset:14528
  ds_read_b64_tr_b16 v[74:75], v14 offset:14528
  v_mfma_f32_16x16x32_bf16 v[132:135], v[84:87], v[44:47], v[132:135]
  v_mfma_f32_16x16x32_bf16 v[136:139], v[84:87], v[48:51], v[136:139]
  v_mfma_f32_16x16x32_bf16 v[140:143], v[88:91], v[44:47], v[140:143]
  v_mfma_f32_16x16x32_bf16 v[144:147], v[88:91], v[48:51], v[144:147]
  v_mfma_f32_16x16x32_bf16 v[148:151], v[76:79], v[44:47], v[148:151]
  v_mfma_f32_16x16x32_bf16 v[156:159], v[44:47], v[44:47], v[156:159]
  v_mfma_f32_16x16x32_bf16 v[152:155], v[76:79], v[48:51], v[152:155]
  v_mfma_f32_16x16x32_bf16 v[160:163], v[48:51], v[48:51], v[160:163]
  s_add_u32 s48, s48, 1
  s_add_u32 s51, s51, 1
  s_cmp_eq_u32 s51, 3
  s_cselect_b32 s49, -90112, s50
  s_cselect_b32 s51, 0, s51
  s_cmp_lt_u32 s48, 10
  s_cbranch_scc1 L_k4_gateup_kernel_10
  s_waitcnt lgkmcnt(0)
  s_nop 7
  s_nop 7
  v_lshlrev_b32 v26, 4, v2
  v_add_u32 v26, 135168, v26
  ds_read_b128 v[52:55], v26 offset:256
  ds_read_b128 v[56:59], v26 offset:704
  ds_read_b128 v[60:63], v26 offset:320
  ds_read_b128 v[64:67], v26 offset:768
  ds_read_b128 v[68:71], v26 offset:384
  ds_read_b128 v[72:75], v26 offset:832
  s_and_b32 s33, s24, 3
  s_lshl_b32 s33, s33, 8
  v_lshlrev_b32 v20, 3, v3
  v_add_u32 v20, s33, v20
  v_and_b32 v16, 3, v3
  v_cmp_eq_u32 vcc, 1, v16
  v_cndmask_b32 v30, v156, v157, vcc
  v_cmp_eq_u32 vcc, 2, v16
  v_cndmask_b32 v30, v30, v158, vcc
  v_cmp_eq_u32 vcc, 3, v16
  v_cndmask_b32 v30, v30, v159, vcc
  v_lshrrev_b32 v16, 2, v3
  v_cmp_eq_u32 vcc, v16, v2
  v_cndmask_b32 v30, 0, v30, vcc
  v_cmp_eq_u32 vcc, 0, v2
  v_cndmask_b32 v29, 0, v148, vcc
  v_and_b32 v16, 3, v3
  v_cmp_eq_u32 vcc, 1, v16
  v_cndmask_b32 v32, v160, v161, vcc
  v_cmp_eq_u32 vcc, 2, v16
  v_cndmask_b32 v32, v32, v162, vcc
  v_cmp_eq_u32 vcc, 3, v16
  v_cndmask_b32 v32, v32, v163, vcc
  v_lshrrev_b32 v16, 2, v3
  v_cmp_eq_u32 vcc, v16, v2
  v_cndmask_b32 v32, 0, v32, vcc
  v_cmp_eq_u32 vcc, 0, v2
  v_cndmask_b32 v31, 0, v152, vcc
  v_mov_b32 v16, v29
  v_mov_b32 v17, v29
  s_nop 1
  v_permlane16_swap_b32 v16, v17
  s_nop 1
  v_add_f32 v29, v16, v17
  v_mov_b32 v16, v29
  v_mov_b32 v17, v29
  s_nop 1
  v_permlane32_swap_b32 v16, v17
  s_nop 1
  v_add_f32 v29, v16, v17
  v_mov_b32 v16, v30
  v_mov_b32 v17, v30
  s_nop 1
  v_permlane16_swap_b32 v16, v17
  s_nop 1
  v_add_f32 v30, v16, v17
  v_mov_b32 v16, v30
  v_mov_b32 v17, v30
  s_nop 1
  v_permlane32_swap_b32 v16, v17
  s_nop 1
  v_add_f32 v30, v16, v17
  v_mul_f32 v22, 0x3acccccd, v29
  v_mul_f32 v16, 0x3acccccd, v30
  v_fma_f32 v16, -v22, v22, v16
  v_max_f32 v16, 0, v16
  v_add_f32 v16, 0x3727c5ac, v16
  v_rsq_f32 v23, v16
  s_nop 0
  v_mov_b32 v16, v31
  v_mov_b32 v17, v31
  s_nop 1
  v_permlane16_swap_b32 v16, v17
  s_nop 1
  v_add_f32 v31, v16, v17
  v_mov_b32 v16, v31
  v_mov_b32 v17, v31
  s_nop 1
  v_permlane32_swap_b32 v16, v17
  s_nop 1
  v_add_f32 v31, v16, v17
  v_mov_b32 v16, v32
  v_mov_b32 v17, v32
  s_nop 1
  v_permlane16_swap_b32 v16, v17
  s_nop 1
  v_add_f32 v32, v16, v17
  v_mov_b32 v16, v32
  v_mov_b32 v17, v32
  s_nop 1
  v_permlane32_swap_b32 v16, v17
  s_nop 1
  v_add_f32 v32, v16, v17
  v_mul_f32 v24, 0x3acccccd, v31
  v_mul_f32 v16, 0x3acccccd, v32
  v_fma_f32 v16, -v24, v24, v16
  v_max_f32 v16, 0, v16
  v_add_f32 v16, 0x3727c5ac, v16
  v_rsq_f32 v25, v16
  s_nop 0
  s_barrier
  ds_write_b64 v20, v[22:23]
  ds_write_b64 v20, v[24:25] offset:128
  s_waitcnt lgkmcnt(0)
  s_barrier
  v_mul_f32 v23, v23, v23
  v_mul_f32 v25, v25, v25
  s_mov_b32 s33, 55296
  s_mul_i32 s34, s26, 112
  v_lshl_add_u32 v27, v2, 3, v28
  s_cmp_gt_u32 s34, 1648
  s_cbranch_scc1 L_k4_gateup_kernel_11
  s_cmp_gt_u32 s34, 1632
  s_cbranch_scc1 L_k4_gateup_kernel_12
  v_fma_f32 v116, -v22, v60, v116
  v_fma_f32 v124, -v22, v64, v124
  v_mul_f32 v116, v116, v23
  v_mul_f32 v116, v116, v124
  v_fma_f32 v117, -v22, v61, v117
  v_fma_f32 v125, -v22, v65, v125
  v_mul_f32 v117, v117, v23
  v_mul_f32 v117, v117, v125
  v_fma_f32 v118, -v22, v62, v118
  v_fma_f32 v126, -v22, v66, v126
  v_mul_f32 v118, v118, v23
  v_mul_f32 v118, v118, v126
  v_fma_f32 v119, -v22, v63, v119
  v_fma_f32 v127, -v22, v67, v127
  v_mul_f32 v119, v119, v23
  v_mul_f32 v119, v119, v127
  v_cvt_pk_bf16_f32 v38, v116, v117
  v_cvt_pk_bf16_f32 v39, v118, v119
  v_fma_f32 v100, -v22, v52, v100
  v_fma_f32 v108, -v22, v56, v108
  v_mul_f32 v100, v100, v23
  v_mul_f32 v100, v100, v108
  v_fma_f32 v101, -v22, v53, v101
  v_fma_f32 v109, -v22, v57, v109
  v_mul_f32 v101, v101, v23
  v_mul_f32 v101, v101, v109
  v_fma_f32 v102, -v22, v54, v102
  v_fma_f32 v110, -v22, v58, v110
  v_mul_f32 v102, v102, v23
  v_mul_f32 v102, v102, v110
  v_fma_f32 v103, -v22, v55, v103
  v_fma_f32 v111, -v22, v59, v111
  v_mul_f32 v103, v103, v23
  v_mul_f32 v103, v103, v111
  v_cvt_pk_bf16_f32 v36, v100, v101
  v_cvt_pk_bf16_f32 v37, v102, v103
  s_nop 1
  v_permlane32_swap_b32 v36, v38
  v_permlane32_swap_b32 v37, v39
  s_nop 1
  v_permlane16_swap_b32 v36, v38
  v_permlane16_swap_b32 v37, v39
  s_nop 1
  buffer_store_dwordx4 v[36:39], v27, s[16:19], 0 offen offset:0
  v_fma_f32 v120, -v24, v60, v120
  v_fma_f32 v128, -v24, v64, v128
  v_mul_f32 v120, v120, v25
  v_mul_f32 v120, v120, v128
  v_fma_f32 v121, -v24, v61, v121
  v_fma_f32 v129, -v24, v65, v129
  v_mul_f32 v121, v121, v25
  v_mul_f32 v121, v121, v129
  v_fma_f32 v122, -v24, v62, v122
  v_fma_f32 v130, -v24, v66, v130
  v_mul_f32 v122, v122, v25
  v_mul_f32 v122, v122, v130
  v_fma_f32 v123, -v24, v63, v123
  v_fma_f32 v131, -v24, v67, v131
  v_mul_f32 v123, v123, v25
  v_mul_f32 v123, v123, v131
  v_cvt_pk_bf16_f32 v42, v120, v121
  v_cvt_pk_bf16_f32 v43, v122, v123
  v_fma_f32 v104, -v24, v52, v104
  v_fma_f32 v112, -v24, v56, v112
  v_mul_f32 v104, v104, v25
  v_mul_f32 v104, v104, v112
  v_fma_f32 v105, -v24, v53, v105
  v_fma_f32 v113, -v24, v57, v113
  v_mul_f32 v105, v105, v25
  v_mul_f32 v105, v105, v113
  v_fma_f32 v106, -v24, v54, v106
  v_fma_f32 v114, -v24, v58, v114
  v_mul_f32 v106, v106, v25
  v_mul_f32 v106, v106, v114
  v_fma_f32 v107, -v24, v55, v107
  v_fma_f32 v115, -v24, v59, v115
  v_mul_f32 v107, v107, v25
  v_mul_f32 v107, v107, v115
  v_cvt_pk_bf16_f32 v40, v104, v105
  v_cvt_pk_bf16_f32 v41, v106, v107
  s_nop 1
  v_permlane32_swap_b32 v40, v42
  v_permlane32_swap_b32 v41, v43
  s_nop 1
  v_permlane16_swap_b32 v40, v42
  v_permlane16_swap_b32 v41, v43
  s_nop 1
  buffer_store_dwordx4 v[40:43], v27, s[16:19], s33 offen offset:0
  s_branch L_k4_gateup_kernel_13
L_k4_gateup_kernel_12:
  v_fma_f32 v100, -v22, v52, v100
  v_fma_f32 v108, -v22, v56, v108
  v_mul_f32 v100, v100, v23
  v_mul_f32 v100, v100, v108
  v_fma_f32 v101, -v22, v53, v101
  v_fma_f32 v109, -v22, v57, v109
  v_mul_f32 v101, v101, v23
  v_mul_f32 v101, v101, v109
  v_fma_f32 v102, -v22, v54, v102
  v_fma_f32 v110, -v22, v58, v110
  v_mul_f32 v102, v102, v23
  v_mul_f32 v102, v102, v110
  v_fma_f32 v103, -v22, v55, v103
  v_fma_f32 v111, -v22, v59, v111
  v_mul_f32 v103, v103, v23
  v_mul_f32 v103, v103, v111
  v_cvt_pk_bf16_f32 v44, v100, v101
  v_cvt_pk_bf16_f32 v45, v102, v103
  buffer_store_dwordx2 v[44:45], v28, s[16:19], 0 offen offset:0
  v_fma_f32 v104, -v24, v52, v104
  v_fma_f32 v112, -v24, v56, v112
  v_mul_f32 v104, v104, v25
  v_mul_f32 v104, v104, v112
  v_fma_f32 v105, -v24, v53, v105
  v_fma_f32 v113, -v24, v57, v113
  v_mul_f32 v105, v105, v25
  v_mul_f32 v105, v105, v113
  v_fma_f32 v106, -v24, v54, v106
  v_fma_f32 v114, -v24, v58, v114
  v_mul_f32 v106, v106, v25
  v_mul_f32 v106, v106, v114
  v_fma_f32 v107, -v24, v55, v107
  v_fma_f32 v115, -v24, v59, v115
  v_mul_f32 v107, v107, v25
  v_mul_f32 v107, v107, v115
  v_cvt_pk_bf16_f32 v46, v104, v105
  v_cvt_pk_bf16_f32 v47, v106, v107
  buffer_store_dwordx2 v[46:47], v28, s[16:19], s33 offen offset:0
  s_branch L_k4_gateup_kernel_11
L_k4_gateup_kernel_13:
  s_cmp_gt_u32 s34, 1616
  s_cbranch_scc1 L_k4_gateup_kernel_11
  v_fma_f32 v132, -v22, v68, v132
  v_fma_f32 v140, -v22, v72, v140
  v_mul_f32 v132, v132, v23
  v_mul_f32 v132, v132, v140
  v_fma_f32 v133, -v22, v69, v133
  v_fma_f32 v141, -v22, v73, v141
  v_mul_f32 v133, v133, v23
  v_mul_f32 v133, v133, v141
  v_fma_f32 v134, -v22, v70, v134
  v_fma_f32 v142, -v22, v74, v142
  v_mul_f32 v134, v134, v23
  v_mul_f32 v134, v134, v142
  v_fma_f32 v135, -v22, v71, v135
  v_fma_f32 v143, -v22, v75, v143
  v_mul_f32 v135, v135, v23
  v_mul_f32 v135, v135, v143
  v_cvt_pk_bf16_f32 v44, v132, v133
  v_cvt_pk_bf16_f32 v45, v134, v135
  buffer_store_dwordx2 v[44:45], v28, s[16:19], 0 offen offset:64
  v_fma_f32 v136, -v24, v68, v136
  v_fma_f32 v144, -v24, v72, v144
  v_mul_f32 v136, v136, v25
  v_mul_f32 v136, v136, v144
  v_fma_f32 v137, -v24, v69, v137
  v_fma_f32 v145, -v24, v73, v145
  v_mul_f32 v137, v137, v25
  v_mul_f32 v137, v137, v145
  v_fma_f32 v138, -v24, v70, v138
  v_fma_f32 v146, -v24, v74, v146
  v_mul_f32 v138, v138, v25
  v_mul_f32 v138, v138, v146
  v_fma_f32 v139, -v24, v71, v139
  v_fma_f32 v147, -v24, v75, v147
  v_mul_f32 v139, v139, v25
  v_mul_f32 v139, v139, v147
  v_cvt_pk_bf16_f32 v46, v136, v137
  v_cvt_pk_bf16_f32 v47, v138, v139
  buffer_store_dwordx2 v[46:47], v28, s[16:19], s33 offen offset:64
L_k4_gateup_kernel_11:
  s_endpgm
L_k4_gateup_kernel_1:
  s_lshl_b32 s33, s25, 7
  s_mul_i32 s33, s33, 1280
  v_lshrrev_b32 v16, 3, v1
  v_and_b32 v17, 7, v1
  v_xor_b32 v17, v17, v16
  v_lshlrev_b32 v17, 4, v17
  v_mul_u32_u24 v16, 1280, v16
  v_add3_u32 v4, v16, v17, s33
  s_mul_i32 s33, s26, 448
  v_lshlrev_b32 v16, 4, v1
  v_add_u32 v16, s33, v16
  v_add_u32 v17, 6464, v16
  v_cmp_lt_u32 vcc, 27, v1
  v_cndmask_b32 v16, v16, v17, vcc
  v_mov_b32 v17, 0x100000
  v_cmp_lt_u32 vcc, 55, v1
  v_cndmask_b32 v16, v16, v17, vcc
  s_waitcnt lgkmcnt(0)
  s_add_u32 s4, s40, 0x600000
  s_addc_u32 s5, s41, 0
  s_mov_b32 s6, 0x280000
  s_mov_b32 s7, 0x20000
  s_add_u32 s8, s40, 0x1500000
  s_addc_u32 s9, s41, 0
  s_mov_b32 s10, 0x460000
  s_mov_b32 s11, 0x20000
  s_add_u32 s16, s40, 0x900000
  s_addc_u32 s17, s41, 0
  s_mov_b32 s18, 0x6c0000
  s_mov_b32 s19, 0x20000
  s_add_u32 s20, s40, 0x1000000
  s_addc_u32 s21, s41, 0
  s_mov_b32 s22, 0x3600
  s_mov_b32 s23, 0x20000
  s_mov_b32 m0, 135168
  s_nop 0
  buffer_load_dwordx4 v16, s[20:23], 0 offen lds
  s_setprio 3
  s_mov_b32 s27, 0
  s_mov_b32 s47, 0
  s_mov_b32 s48, 0
L_k4_gateup_kernel_14:
  s_cmp_lt_u32 s48, 2
  s_cbranch_scc1 L_k4_gateup_kernel_15
  s_waitcnt vmcnt(16)
  s_barrier
L_k4_gateup_kernel_15:
  s_add_u32 m0, s47, 0
  s_add_u32 s33, s27, 0
  buffer_load_dwordx4 v4, s[4:7], s33 offen lds
  s_add_u32 m0, s47, 1024
  s_add_u32 s33, s27, 10240
  buffer_load_dwordx4 v4, s[4:7], s33 offen lds
  s_add_u32 m0, s47, 2048
  s_add_u32 s33, s27, 20480
  buffer_load_dwordx4 v4, s[4:7], s33 offen lds
  s_add_u32 m0, s47, 3072
  s_add_u32 s33, s27, 30720
  buffer_load_dwordx4 v4, s[4:7], s33 offen lds
  s_add_u32 m0, s47, 4096
  s_add_u32 s33, s27, 40960
  buffer_load_dwordx4 v4, s[4:7], s33 offen lds
  s_add_u32 m0, s47, 5120
  s_add_u32 s33, s27, 51200
  buffer_load_dwordx4 v4, s[4:7], s33 offen lds
  s_add_u32 m0, s47, 6144
  s_add_u32 s33, s27, 61440
  buffer_load_dwordx4 v4, s[4:7], s33 offen lds
  s_add_u32 m0, s47, 7168
  s_add_u32 s33, s27, 71680
  buffer_load_dwordx4 v4, s[4:7], s33 offen lds
  s_add_u32 m0, s47, 8192
  s_add_u32 s33, s27, 81920
  buffer_load_dwordx4 v4, s[4:7], s33 offen lds
  s_add_u32 m0, s47, 9216
  s_add_u32 s33, s27, 92160
  buffer_load_dwordx4 v4, s[4:7], s33 offen lds
  s_add_u32 m0, s47, 10240
  s_add_u32 s33, s27, 102400
  buffer_load_dwordx4 v4, s[4:7], s33 offen lds
  s_add_u32 m0, s47, 11264
  s_add_u32 s33, s27, 112640
  buffer_load_dwordx4 v4, s[4:7], s33 offen lds
  s_add_u32 m0, s47, 12288
  s_add_u32 s33, s27, 122880
  buffer_load_dwordx4 v4, s[4:7], s33 offen lds
  s_add_u32 m0, s47, 13312
  s_add_u32 s33, s27, 133120
  buffer_load_dwordx4 v4, s[4:7], s33 offen lds
  s_add_u32 m0, s47, 14336
  s_add_u32 s33, s27, 143360
  buffer_load_dwordx4 v4, s[4:7], s33 offen lds
  s_add_u32 m0, s47, 15360
  s_add_u32 s33, s27, 153600
  buffer_load_dwordx4 v4, s[4:7], s33 offen lds
  s_add_u32 s27, s27, 128
  s_add_u32 s47, s47, 45056
  s_cmp_eq_u32 s47, 135168
  s_cselect_b32 s47, 0, s47
  s_add_u32 s48, s48, 1
  s_cmp_lt_u32 s48, 10
  s_cbranch_scc1 L_k4_gateup_kernel_14
  s_waitcnt vmcnt(16)
  s_barrier
  s_waitcnt vmcnt(0)
  s_barrier
  s_barrier
  s_endpgm
L_k4_gateup_kernel_2:
  s_mul_i32 s33, s26, 286720
  v_lshlrev_b32 v4, 4, v1
  v_add_u32 v4, s33, v4
  s_waitcnt lgkmcnt(0)
  s_add_u32 s4, s40, 0x600000
  s_addc_u32 s5, s41, 0
  s_mov_b32 s6, 0x280000
  s_mov_b32 s7, 0x20000
  s_add_u32 s8, s40, 0x1500000
  s_addc_u32 s9, s41, 0
  s_mov_b32 s10, 0x460000
  s_mov_b32 s11, 0x20000
  s_add_u32 s16, s40, 0x900000
  s_addc_u32 s17, s41, 0
  s_mov_b32 s18, 0x6c0000
  s_mov_b32 s19, 0x20000
  s_add_u32 s20, s40, 0x1000000
  s_addc_u32 s21, s41, 0
  s_mov_b32 s22, 0x3600
  s_mov_b32 s23, 0x20000
  s_setprio 3
  s_mov_b32 s27, 0
  s_mov_b32 s47, 0
  s_mov_b32 s48, 0
L_k4_gateup_kernel_16:
  s_cmp_lt_u32 s48, 2
  s_cbranch_scc1 L_k4_gateup_kernel_17
  s_waitcnt vmcnt(28)
  s_barrier
L_k4_gateup_kernel_17:
  s_add_u32 m0, s47, 16384
  s_add_u32 s33, s27, 0
  buffer_load_dwordx4 v4, s[8:11], s33 offen lds
  s_add_u32 m0, s47, 17408
  s_add_u32 s33, s27, 1024
  buffer_load_dwordx4 v4, s[8:11], s33 offen lds
  s_add_u32 m0, s47, 18432
  s_add_u32 s33, s27, 2048
  buffer_load_dwordx4 v4, s[8:11], s33 offen lds
  s_add_u32 m0, s47, 19456
  s_add_u32 s33, s27, 3072
  buffer_load_dwordx4 v4, s[8:11], s33 offen lds
  s_add_u32 m0, s47, 20480
  s_add_u32 s33, s27, 4096
  buffer_load_dwordx4 v4, s[8:11], s33 offen lds
  s_add_u32 m0, s47, 21504
  s_add_u32 s33, s27, 5120
  buffer_load_dwordx4 v4, s[8:11], s33 offen lds
  s_add_u32 m0, s47, 22528
  s_add_u32 s33, s27, 6144
  buffer_load_dwordx4 v4, s[8:11], s33 offen lds
  s_add_u32 m0, s47, 23552
  s_add_u32 s33, s27, 7168
  buffer_load_dwordx4 v4, s[8:11], s33 offen lds
  s_add_u32 m0, s47, 24576
  s_add_u32 s33, s27, 8192
  buffer_load_dwordx4 v4, s[8:11], s33 offen lds
  s_add_u32 m0, s47, 25600
  s_add_u32 s33, s27, 9216
  buffer_load_dwordx4 v4, s[8:11], s33 offen lds
  s_add_u32 m0, s47, 26624
  s_add_u32 s33, s27, 10240
  buffer_load_dwordx4 v4, s[8:11], s33 offen lds
  s_add_u32 m0, s47, 27648
  s_add_u32 s33, s27, 11264
  buffer_load_dwordx4 v4, s[8:11], s33 offen lds
  s_add_u32 m0, s47, 28672
  s_add_u32 s33, s27, 12288
  buffer_load_dwordx4 v4, s[8:11], s33 offen lds
  s_add_u32 m0, s47, 29696
  s_add_u32 s33, s27, 13312
  buffer_load_dwordx4 v4, s[8:11], s33 offen lds
  s_add_u32 m0, s47, 30720
  s_add_u32 s33, s27, 14336
  buffer_load_dwordx4 v4, s[8:11], s33 offen lds
  s_add_u32 m0, s47, 31744
  s_add_u32 s33, s27, 15360
  buffer_load_dwordx4 v4, s[8:11], s33 offen lds
  s_add_u32 m0, s47, 32768
  s_add_u32 s33, s27, 16384
  buffer_load_dwordx4 v4, s[8:11], s33 offen lds
  s_add_u32 m0, s47, 33792
  s_add_u32 s33, s27, 17408
  buffer_load_dwordx4 v4, s[8:11], s33 offen lds
  s_add_u32 m0, s47, 34816
  s_add_u32 s33, s27, 18432
  buffer_load_dwordx4 v4, s[8:11], s33 offen lds
  s_add_u32 m0, s47, 35840
  s_add_u32 s33, s27, 19456
  buffer_load_dwordx4 v4, s[8:11], s33 offen lds
  s_add_u32 m0, s47, 36864
  s_add_u32 s33, s27, 20480
  buffer_load_dwordx4 v4, s[8:11], s33 offen lds
  s_add_u32 m0, s47, 37888
  s_add_u32 s33, s27, 21504
  buffer_load_dwordx4 v4, s[8:11], s33 offen lds
  s_add_u32 m0, s47, 38912
  s_add_u32 s33, s27, 22528
  buffer_load_dwordx4 v4, s[8:11], s33 offen lds
  s_add_u32 m0, s47, 39936
  s_add_u32 s33, s27, 23552
  buffer_load_dwordx4 v4, s[8:11], s33 offen lds
  s_add_u32 m0, s47, 40960
  s_add_u32 s33, s27, 24576
  buffer_load_dwordx4 v4, s[8:11], s33 offen lds
  s_add_u32 m0, s47, 41984
  s_add_u32 s33, s27, 25600
  buffer_load_dwordx4 v4, s[8:11], s33 offen lds
  s_add_u32 m0, s47, 43008
  s_add_u32 s33, s27, 26624
  buffer_load_dwordx4 v4, s[8:11], s33 offen lds
  s_add_u32 m0, s47, 44032
  s_add_u32 s33, s27, 27648
  buffer_load_dwordx4 v4, s[8:11], s33 offen lds
  s_add_u32 s27, s27, 28672
  s_add_u32 s47, s47, 45056
  s_cmp_eq_u32 s47, 135168
  s_cselect_b32 s47, 0, s47
  s_add_u32 s48, s48, 1
  s_cmp_lt_u32 s48, 10
  s_cbranch_scc1 L_k4_gateup_kernel_16
  s_waitcnt vmcnt(28)
  s_barrier
  s_waitcnt vmcnt(0)
  s_barrier
  s_barrier
  s_endpgm
L_k4_gateup_kernel_end:
  s_endpgm
.globl k5_down_kernel
.p2align 8
.type k5_down_kernel,@function
k5_down_kernel:
  s_cmp_ge_u32 s2, 256
  s_cbranch_scc1 L_k5_down_kernel_end
  s_load_dwordx2 s[44:45], s[0:1], 88
  s_load_dwordx2 s[50:51], s[0:1], 72
  v_and_b32 v1, 63, v0
  v_lshrrev_b32 v22, 6, v0
  v_lshrrev_b32 v2, 4, v1
  v_readfirstlane_b32 s24, v22
  v_and_b32 v3, 15, v1
  s_and_b32 s33, s2, 7
  s_lshr_b32 s26, s2, 3
  s_lshl_b32 s25, s33, 2
  s_lshr_b32 s33, s26, 3
  s_add_u32 s25, s25, s33
  s_and_b32 s26, s26, 7
  s_cmp_eq_u32 s24, 4
  s_cbranch_scc1 L_k5_down_kernel_1
  s_cmp_eq_u32 s24, 5
  s_cbranch_scc1 L_k5_down_kernel_2
  s_waitcnt lgkmcnt(0)
  s_add_u32 s4, s44, 0x900000
  s_addc_u32 s5, s45, 0
  s_mov_b32 s6, 0x6c0000
  s_mov_b32 s7, 0x20000
  s_add_u32 s8, s44, 0x1200000
  s_addc_u32 s9, s45, 0
  s_mov_b32 s10, 0x230000
  s_mov_b32 s11, 0x20000
  s_add_u32 s12, s44, 0x600000
  s_addc_u32 s13, s45, 0
  s_mov_b32 s14, 0x280000
  s_mov_b32 s15, 0x20000
  s_mov_b32 s16, s50
  s_mov_b32 s17, s51
  s_mov_b32 s18, 0x280000
  s_mov_b32 s19, 0x20000
  s_and_b32 s33, s24, 1
  s_lshl_b32 s33, s33, 13
  v_xor_b32 v22, v2, v3
  v_lshlrev_b32 v23, 8, v3
  v_add_u32 v23, s33, v23
  v_xor_b32 v24, 0, v22
  v_lshl_add_u32 v14, v24, 4, v23
  v_xor_b32 v24, 4, v22
  v_lshl_add_u32 v15, v24, 4, v23
  v_xor_b32 v24, 8, v22
  v_lshl_add_u32 v16, v24, 4, v23
  v_xor_b32 v24, 12, v22
  v_lshl_add_u32 v17, v24, 4, v23
  v_lshrrev_b32 v22, 2, v1
  v_and_b32 v22, 3, v22
  v_and_b32 v23, 1, v2
  v_lshlrev_b32 v23, 2, v23
  v_xor_b32 v22, v22, v23
  v_lshl_add_u32 v22, v2, 3, v22
  v_xor_b32 v23, 4, v22
  v_and_b32 v24, 3, v1
  v_lshlrev_b32 v24, 3, v24
  v_mul_u32_u24 v18, 160, v22
  v_mul_u32_u24 v19, 160, v23
  v_add3_u32 v18, v18, v24, 0
  v_add_u32 v19, v19, v24
  v_add_u32 v18, 16384, v18
  v_add_u32 v19, 16384, v19
  s_lshl_b32 s33, s25, 6
  s_and_b32 s34, s24, 1
  s_lshl_b32 s34, s34, 5
  s_add_u32 s33, s33, s34
  v_add_u32 v22, s33, v3
  v_mul_u32_u24 v128, 1280, v22
  s_mul_i32 s33, s26, 160
  s_lshr_b32 s34, s24, 1
  s_mul_i32 s34, s34, 96
  s_add_u32 s33, s33, s34
  v_lshlrev_b32 v22, 3, v2
  v_add3_u32 v128, v128, v22, s33
  v_mov_b32 v72, 0
  v_mov_b32 v73, 0
  v_mov_b32 v74, 0
  v_mov_b32 v75, 0
  v_mov_b32 v76, 0
  v_mov_b32 v77, 0
  v_mov_b32 v78, 0
  v_mov_b32 v79, 0
  v_mov_b32 v80, 0
  v_mov_b32 v81, 0
  v_mov_b32 v82, 0
  v_mov_b32 v83, 0
  v_mov_b32 v84, 0
  v_mov_b32 v85, 0
  v_mov_b32 v86, 0
  v_mov_b32 v87, 0
  v_mov_b32 v88, 0
  v_mov_b32 v89, 0
  v_mov_b32 v90, 0
  v_mov_b32 v91, 0
  v_mov_b32 v92, 0
  v_mov_b32 v93, 0
  v_mov_b32 v94, 0
  v_mov_b32 v95, 0
  s_mov_b32 s35, 0
  s_mov_b32 s36, 20480
  s_cmp_ge_u32 s24, 2
  s_cbranch_scc1 L_k5_down_kernel_3
  s_mov_b32 s56, 0
  s_mov_b32 s57, 0
  s_mov_b32 s59, 36864
L_k5_down_kernel_4:
  s_barrier
  v_add_u32 v14, s57, v14
  v_add_u32 v15, s57, v15
  v_add_u32 v16, s57, v16
  v_add_u32 v17, s57, v17
  v_add_u32 v18, s57, v18
  v_add_u32 v19, s57, v19
  ds_read_b128 v[32:35], v14 offset:0
  ds_read_b128 v[36:39], v14 offset:4096
  ds_read_b64_tr_b16 v[48:49], v18 offset:0
  ds_read_b64_tr_b16 v[50:51], v19 offset:0
  ds_read_b64_tr_b16 v[52:53], v18 offset:32
  ds_read_b64_tr_b16 v[54:55], v19 offset:32
  ds_read_b64_tr_b16 v[56:57], v18 offset:64
  ds_read_b64_tr_b16 v[58:59], v19 offset:64
  ds_read_b128 v[40:43], v15 offset:0
  ds_read_b128 v[44:47], v15 offset:4096
  ds_read_b64_tr_b16 v[60:61], v18 offset:5120
  ds_read_b64_tr_b16 v[62:63], v19 offset:5120
  ds_read_b64_tr_b16 v[64:65], v18 offset:5152
  ds_read_b64_tr_b16 v[66:67], v19 offset:5152
  ds_read_b64_tr_b16 v[68:69], v18 offset:5184
  ds_read_b64_tr_b16 v[70:71], v19 offset:5184
  s_waitcnt lgkmcnt(8)
  v_mfma_f32_16x16x32_bf16 v[72:75], v[48:51], v[32:35], v[72:75]
  v_mfma_f32_16x16x32_bf16 v[76:79], v[48:51], v[36:39], v[76:79]
  v_mfma_f32_16x16x32_bf16 v[80:83], v[52:55], v[32:35], v[80:83]
  v_mfma_f32_16x16x32_bf16 v[84:87], v[52:55], v[36:39], v[84:87]
  v_mfma_f32_16x16x32_bf16 v[88:91], v[56:59], v[32:35], v[88:91]
  v_mfma_f32_16x16x32_bf16 v[92:95], v[56:59], v[36:39], v[92:95]
  ds_read_b128 v[32:35], v16 offset:0
  ds_read_b128 v[36:39], v16 offset:4096
  ds_read_b64_tr_b16 v[48:49], v18 offset:10240
  ds_read_b64_tr_b16 v[50:51], v19 offset:10240
  ds_read_b64_tr_b16 v[52:53], v18 offset:10272
  ds_read_b64_tr_b16 v[54:55], v19 offset:10272
  ds_read_b64_tr_b16 v[56:57], v18 offset:10304
  ds_read_b64_tr_b16 v[58:59], v19 offset:10304
  s_waitcnt lgkmcnt(8)
  v_mfma_f32_16x16x32_bf16 v[72:75], v[60:63], v[40:43], v[72:75]
  v_mfma_f32_16x16x32_bf16 v[76:79], v[60:63], v[44:47], v[76:79]
  v_mfma_f32_16x16x32_bf16 v[80:83], v[64:67], v[40:43], v[80:83]
  v_mfma_f32_16x16x32_bf16 v[84:87], v[64:67], v[44:47], v[84:87]
  v_mfma_f32_16x16x32_bf16 v[88:91], v[68:71], v[40:43], v[88:91]
  v_mfma_f32_16x16x32_bf16 v[92:95], v[68:71], v[44:47], v[92:95]
  ds_read_b128 v[40:43], v17 offset:0
  ds_read_b128 v[44:47], v17 offset:4096
  ds_read_b64_tr_b16 v[60:61], v18 offset:15360
  ds_read_b64_tr_b16 v[62:63], v19 offset:15360
  ds_read_b64_tr_b16 v[64:65], v18 offset:15392
  ds_read_b64_tr_b16 v[66:67], v19 offset:15392
  ds_read_b64_tr_b16 v[68:69], v18 offset:15424
  ds_read_b64_tr_b16 v[70:71], v19 offset:15424
  s_waitcnt lgkmcnt(8)
  v_mfma_f32_16x16x32_bf16 v[72:75], v[48:51], v[32:35], v[72:75]
  v_mfma_f32_16x16x32_bf16 v[76:79], v[48:51], v[36:39], v[76:79]
  v_mfma_f32_16x16x32_bf16 v[80:83], v[52:55], v[32:35], v[80:83]
  v_mfma_f32_16x16x32_bf16 v[84:87], v[52:55], v[36:39], v[84:87]
  v_mfma_f32_16x16x32_bf16 v[88:91], v[56:59], v[32:35], v[88:91]
  v_mfma_f32_16x16x32_bf16 v[92:95], v[56:59], v[36:39], v[92:95]
  s_waitcnt lgkmcnt(0)
  v_mfma_f32_16x16x32_bf16 v[72:75], v[60:63], v[40:43], v[72:75]
  v_mfma_f32_16x16x32_bf16 v[76:79], v[60:63], v[44:47], v[76:79]
  v_mfma_f32_16x16x32_bf16 v[80:83], v[64:67], v[40:43], v[80:83]
  v_mfma_f32_16x16x32_bf16 v[84:87], v[64:67], v[44:47], v[84:87]
  v_mfma_f32_16x16x32_bf16 v[88:91], v[68:71], v[40:43], v[88:91]
  v_mfma_f32_16x16x32_bf16 v[92:95], v[68:71], v[44:47], v[92:95]
  s_cmp_eq_u32 s56, 1
  s_cbranch_scc0 L_k5_down_kernel_5
  buffer_load_dwordx2 v[116:117], v128, s[12:15], s35 offen offset:0
  buffer_load_dwordx2 v[118:119], v128, s[12:15], s36 offen offset:0
  buffer_load_dwordx2 v[120:121], v128, s[12:15], s35 offen offset:32
  buffer_load_dwordx2 v[122:123], v128, s[12:15], s36 offen offset:32
  buffer_load_dwordx2 v[124:125], v128, s[12:15], s35 offen offset:64
  buffer_load_dwordx2 v[126:127], v128, s[12:15], s36 offen offset:64
L_k5_down_kernel_5:
  s_add_u32 s56, s56, 1
  s_and_b32 s33, s56, 3
  s_cmp_eq_u32 s33, 0
  s_cselect_b32 s57, -110592, s59
  s_cmp_lt_u32 s56, 13
  s_cbranch_scc1 L_k5_down_kernel_4
  s_barrier
  v_add_u32 v14, s57, v14
  v_add_u32 v15, s57, v15
  v_add_u32 v16, s57, v16
  v_add_u32 v17, s57, v17
  v_add_u32 v18, s57, v18
  v_add_u32 v19, s57, v19
  ds_read_b128 v[32:35], v14 offset:0
  ds_read_b128 v[36:39], v14 offset:4096
  ds_read_b64_tr_b16 v[48:49], v18 offset:0
  ds_read_b64_tr_b16 v[50:51], v19 offset:0
  ds_read_b64_tr_b16 v[52:53], v18 offset:32
  ds_read_b64_tr_b16 v[54:55], v19 offset:32
  ds_read_b64_tr_b16 v[56:57], v18 offset:64
  ds_read_b64_tr_b16 v[58:59], v19 offset:64
  ds_read_b128 v[40:43], v15 offset:0
  ds_read_b128 v[44:47], v15 offset:4096
  ds_read_b64_tr_b16 v[60:61], v18 offset:5120
  ds_read_b64_tr_b16 v[62:63], v19 offset:5120
  ds_read_b64_tr_b16 v[64:65], v18 offset:5152
  ds_read_b64_tr_b16 v[66:67], v19 offset:5152
  ds_read_b64_tr_b16 v[68:69], v18 offset:5184
  ds_read_b64_tr_b16 v[70:71], v19 offset:5184
  s_waitcnt lgkmcnt(8)
  v_mfma_f32_16x16x32_bf16 v[72:75], v[48:51], v[32:35], v[72:75]
  v_mfma_f32_16x16x32_bf16 v[76:79], v[48:51], v[36:39], v[76:79]
  v_mfma_f32_16x16x32_bf16 v[80:83], v[52:55], v[32:35], v[80:83]
  v_mfma_f32_16x16x32_bf16 v[84:87], v[52:55], v[36:39], v[84:87]
  v_mfma_f32_16x16x32_bf16 v[88:91], v[56:59], v[32:35], v[88:91]
  v_mfma_f32_16x16x32_bf16 v[92:95], v[56:59], v[36:39], v[92:95]
  s_waitcnt lgkmcnt(0)
  v_mfma_f32_16x16x32_bf16 v[72:75], v[60:63], v[40:43], v[72:75]
  v_mfma_f32_16x16x32_bf16 v[76:79], v[60:63], v[44:47], v[76:79]
  v_mfma_f32_16x16x32_bf16 v[80:83], v[64:67], v[40:43], v[80:83]
  v_mfma_f32_16x16x32_bf16 v[84:87], v[64:67], v[44:47], v[84:87]
  v_mfma_f32_16x16x32_bf16 v[88:91], v[68:71], v[40:43], v[88:91]
  v_mfma_f32_16x16x32_bf16 v[92:95], v[68:71], v[44:47], v[92:95]
  s_waitcnt vmcnt(0)
  s_nop 7
  s_nop 7
  v_lshlrev_b32 v22, 16, v116
  v_and_b32 v23, 0xffff0000, v116
  v_lshlrev_b32 v24, 16, v117
  v_and_b32 v25, 0xffff0000, v117
  v_add_f32 v72, v72, v22
  v_add_f32 v73, v73, v23
  v_add_f32 v74, v74, v24
  v_add_f32 v75, v75, v25
  v_cvt_pk_bf16_f32 v72, v72, v73
  v_cvt_pk_bf16_f32 v73, v74, v75
  buffer_store_dwordx2 v[72:73], v128, s[16:19], s35 offen offset:0
  v_lshlrev_b32 v22, 16, v118
  v_and_b32 v23, 0xffff0000, v118
  v_lshlrev_b32 v24, 16, v119
  v_and_b32 v25, 0xffff0000, v119
  v_add_f32 v76, v76, v22
  v_add_f32 v77, v77, v23
  v_add_f32 v78, v78, v24
  v_add_f32 v79, v79, v25
  v_cvt_pk_bf16_f32 v76, v76, v77
  v_cvt_pk_bf16_f32 v77, v78, v79
  buffer_store_dwordx2 v[76:77], v128, s[16:19], s36 offen offset:0
  v_lshlrev_b32 v22, 16, v120
  v_and_b32 v23, 0xffff0000, v120
  v_lshlrev_b32 v24, 16, v121
  v_and_b32 v25, 0xffff0000, v121
  v_add_f32 v80, v80, v22
  v_add_f32 v81, v81, v23
  v_add_f32 v82, v82, v24
  v_add_f32 v83, v83, v25
  v_cvt_pk_bf16_f32 v80, v80, v81
  v_cvt_pk_bf16_f32 v81, v82, v83
  buffer_store_dwordx2 v[80:81], v128, s[16:19], s35 offen offset:32
  v_lshlrev_b32 v22, 16, v122
  v_and_b32 v23, 0xffff0000, v122
  v_lshlrev_b32 v24, 16, v123
  v_and_b32 v25, 0xffff0000, v123
  v_add_f32 v84, v84, v22
  v_add_f32 v85, v85, v23
  v_add_f32 v86, v86, v24
  v_add_f32 v87, v87, v25
  v_cvt_pk_bf16_f32 v84, v84, v85
  v_cvt_pk_bf16_f32 v85, v86, v87
  buffer_store_dwordx2 v[84:85], v128, s[16:19], s36 offen offset:32
  v_lshlrev_b32 v22, 16, v124
  v_and_b32 v23, 0xffff0000, v124
  v_lshlrev_b32 v24, 16, v125
  v_and_b32 v25, 0xffff0000, v125
  v_add_f32 v88, v88, v22
  v_add_f32 v89, v89, v23
  v_add_f32 v90, v90, v24
  v_add_f32 v91, v91, v25
  v_cvt_pk_bf16_f32 v88, v88, v89
  v_cvt_pk_bf16_f32 v89, v90, v91
  buffer_store_dwordx2 v[88:89], v128, s[16:19], s35 offen offset:64
  v_lshlrev_b32 v22, 16, v126
  v_and_b32 v23, 0xffff0000, v126
  v_lshlrev_b32 v24, 16, v127
  v_and_b32 v25, 0xffff0000, v127
  v_add_f32 v92, v92, v22
  v_add_f32 v93, v93, v23
  v_add_f32 v94, v94, v24
  v_add_f32 v95, v95, v25
  v_cvt_pk_bf16_f32 v92, v92, v93
  v_cvt_pk_bf16_f32 v93, v94, v95
  buffer_store_dwordx2 v[92:93], v128, s[16:19], s36 offen offset:64
  s_endpgm
L_k5_down_kernel_3:
  s_mov_b32 s56, 0
  s_mov_b32 s57, 0
  s_mov_b32 s59, 36864
L_k5_down_kernel_6:
  s_barrier
  v_add_u32 v14, s57, v14
  v_add_u32 v15, s57, v15
  v_add_u32 v16, s57, v16
  v_add_u32 v17, s57, v17
  v_add_u32 v18, s57, v18
  v_add_u32 v19, s57, v19
  ds_read_b128 v[32:35], v14 offset:0
  ds_read_b128 v[36:39], v14 offset:4096
  ds_read_b64_tr_b16 v[48:49], v18 offset:96
  ds_read_b64_tr_b16 v[50:51], v19 offset:96
  ds_read_b64_tr_b16 v[52:53], v18 offset:128
  ds_read_b64_tr_b16 v[54:55], v19 offset:128
  ds_read_b128 v[40:43], v15 offset:0
  ds_read_b128 v[44:47], v15 offset:4096
  ds_read_b64_tr_b16 v[60:61], v18 offset:5216
  ds_read_b64_tr_b16 v[62:63], v19 offset:5216
  ds_read_b64_tr_b16 v[64:65], v18 offset:5248
  ds_read_b64_tr_b16 v[66:67], v19 offset:5248
  s_waitcnt lgkmcnt(6)
  v_mfma_f32_16x16x32_bf16 v[72:75], v[48:51], v[32:35], v[72:75]
  v_mfma_f32_16x16x32_bf16 v[76:79], v[48:51], v[36:39], v[76:79]
  v_mfma_f32_16x16x32_bf16 v[80:83], v[52:55], v[32:35], v[80:83]
  v_mfma_f32_16x16x32_bf16 v[84:87], v[52:55], v[36:39], v[84:87]
  ds_read_b128 v[32:35], v16 offset:0
  ds_read_b128 v[36:39], v16 offset:4096
  ds_read_b64_tr_b16 v[48:49], v18 offset:10336
  ds_read_b64_tr_b16 v[50:51], v19 offset:10336
  ds_read_b64_tr_b16 v[52:53], v18 offset:10368
  ds_read_b64_tr_b16 v[54:55], v19 offset:10368
  s_waitcnt lgkmcnt(6)
  v_mfma_f32_16x16x32_bf16 v[72:75], v[60:63], v[40:43], v[72:75]
  v_mfma_f32_16x16x32_bf16 v[76:79], v[60:63], v[44:47], v[76:79]
  v_mfma_f32_16x16x32_bf16 v[80:83], v[64:67], v[40:43], v[80:83]
  v_mfma_f32_16x16x32_bf16 v[84:87], v[64:67], v[44:47], v[84:87]
  ds_read_b128 v[40:43], v17 offset:0
  ds_read_b128 v[44:47], v17 offset:4096
  ds_read_b64_tr_b16 v[60:61], v18 offset:15456
  ds_read_b64_tr_b16 v[62:63], v19 offset:15456
  ds_read_b64_tr_b16 v[64:65], v18 offset:15488
  ds_read_b64_tr_b16 v[66:67], v19 offset:15488
  s_waitcnt lgkmcnt(6)
  v_mfma_f32_16x16x32_bf16 v[72:75], v[48:51], v[32:35], v[72:75]
  v_mfma_f32_16x16x32_bf16 v[76:79], v[48:51], v[36:39], v[76:79]
  v_mfma_f32_16x16x32_bf16 v[80:83], v[52:55], v[32:35], v[80:83]
  v_mfma_f32_16x16x32_bf16 v[84:87], v[52:55], v[36:39], v[84:87]
  s_waitcnt lgkmcnt(0)
  v_mfma_f32_16x16x32_bf16 v[72:75], v[60:63], v[40:43], v[72:75]
  v_mfma_f32_16x16x32_bf16 v[76:79], v[60:63], v[44:47], v[76:79]
  v_mfma_f32_16x16x32_bf16 v[80:83], v[64:67], v[40:43], v[80:83]
  v_mfma_f32_16x16x32_bf16 v[84:87], v[64:67], v[44:47], v[84:87]
  s_cmp_eq_u32 s56, 1
  s_cbranch_scc0 L_k5_down_kernel_7
  buffer_load_dwordx2 v[116:117], v128, s[12:15], s35 offen offset:0
  buffer_load_dwordx2 v[118:119], v128, s[12:15], s36 offen offset:0
  buffer_load_dwordx2 v[120:121], v128, s[12:15], s35 offen offset:32
  buffer_load_dwordx2 v[122:123], v128, s[12:15], s36 offen offset:32
L_k5_down_kernel_7:
  s_add_u32 s56, s56, 1
  s_and_b32 s33, s56, 3
  s_cmp_eq_u32 s33, 0
  s_cselect_b32 s57, -110592, s59
  s_cmp_lt_u32 s56, 13
  s_cbranch_scc1 L_k5_down_kernel_6
  s_barrier
  v_add_u32 v14, s57, v14
  v_add_u32 v15, s57, v15
  v_add_u32 v16, s57, v16
  v_add_u32 v17, s57, v17
  v_add_u32 v18, s57, v18
  v_add_u32 v19, s57, v19
  ds_read_b128 v[32:35], v14 offset:0
  ds_read_b128 v[36:39], v14 offset:4096
  ds_read_b64_tr_b16 v[48:49], v18 offset:96
  ds_read_b64_tr_b16 v[50:51], v19 offset:96
  ds_read_b64_tr_b16 v[52:53], v18 offset:128
  ds_read_b64_tr_b16 v[54:55], v19 offset:128
  ds_read_b128 v[40:43], v15 offset:0
  ds_read_b128 v[44:47], v15 offset:4096
  ds_read_b64_tr_b16 v[60:61], v18 offset:5216
  ds_read_b64_tr_b16 v[62:63], v19 offset:5216
  ds_read_b64_tr_b16 v[64:65], v18 offset:5248
  ds_read_b64_tr_b16 v[66:67], v19 offset:5248
  s_waitcnt lgkmcnt(6)
  v_mfma_f32_16x16x32_bf16 v[72:75], v[48:51], v[32:35], v[72:75]
  v_mfma_f32_16x16x32_bf16 v[76:79], v[48:51], v[36:39], v[76:79]
  v_mfma_f32_16x16x32_bf16 v[80:83], v[52:55], v[32:35], v[80:83]
  v_mfma_f32_16x16x32_bf16 v[84:87], v[52:55], v[36:39], v[84:87]
  s_waitcnt lgkmcnt(0)
  v_mfma_f32_16x16x32_bf16 v[72:75], v[60:63], v[40:43], v[72:75]
  v_mfma_f32_16x16x32_bf16 v[76:79], v[60:63], v[44:47], v[76:79]
  v_mfma_f32_16x16x32_bf16 v[80:83], v[64:67], v[40:43], v[80:83]
  v_mfma_f32_16x16x32_bf16 v[84:87], v[64:67], v[44:47], v[84:87]
  s_waitcnt vmcnt(0)
  s_nop 7
  s_nop 7
  v_lshlrev_b32 v22, 16, v116
  v_and_b32 v23, 0xffff0000, v116
  v_lshlrev_b32 v24, 16, v117
  v_and_b32 v25, 0xffff0000, v117
  v_add_f32 v72, v72, v22
  v_add_f32 v73, v73, v23
  v_add_f32 v74, v74, v24
  v_add_f32 v75, v75, v25
  v_cvt_pk_bf16_f32 v72, v72, v73
  v_cvt_pk_bf16_f32 v73, v74, v75
  buffer_store_dwordx2 v[72:73], v128, s[16:19], s35 offen offset:0
  v_lshlrev_b32 v22, 16, v118
  v_and_b32 v23, 0xffff0000, v118
  v_lshlrev_b32 v24, 16, v119
  v_and_b32 v25, 0xffff0000, v119
  v_add_f32 v76, v76, v22
  v_add_f32 v77, v77, v23
  v_add_f32 v78, v78, v24
  v_add_f32 v79, v79, v25
  v_cvt_pk_bf16_f32 v76, v76, v77
  v_cvt_pk_bf16_f32 v77, v78, v79
  buffer_store_dwordx2 v[76:77], v128, s[16:19], s36 offen offset:0
  v_lshlrev_b32 v22, 16, v120
  v_and_b32 v23, 0xffff0000, v120
  v_lshlrev_b32 v24, 16, v121
  v_and_b32 v25, 0xffff0000, v121
  v_add_f32 v80, v80, v22
  v_add_f32 v81, v81, v23
  v_add_f32 v82, v82, v24
  v_add_f32 v83, v83, v25
  v_cvt_pk_bf16_f32 v80, v80, v81
  v_cvt_pk_bf16_f32 v81, v82, v83
  buffer_store_dwordx2 v[80:81], v128, s[16:19], s35 offen offset:32
  v_lshlrev_b32 v22, 16, v122
  v_and_b32 v23, 0xffff0000, v122
  v_lshlrev_b32 v24, 16, v123
  v_and_b32 v25, 0xffff0000, v123
  v_add_f32 v84, v84, v22
  v_add_f32 v85, v85, v23
  v_add_f32 v86, v86, v24
  v_add_f32 v87, v87, v25
  v_cvt_pk_bf16_f32 v84, v84, v85
  v_cvt_pk_bf16_f32 v85, v86, v87
  buffer_store_dwordx2 v[84:85], v128, s[16:19], s36 offen offset:32
  s_endpgm
L_k5_down_kernel_1:
  s_lshl_b32 s33, s25, 6
  s_mul_i32 s33, s33, 3456
  v_add_u32 v22, 0, v2
  v_xor_b32 v23, v22, v3
  v_lshlrev_b32 v23, 4, v23
  v_mul_u32_u24 v22, 3456, v22
  v_add3_u32 v4, v22, v23, s33
  v_add_u32 v22, 4, v2
  v_xor_b32 v23, v22, v3
  v_lshlrev_b32 v23, 4, v23
  v_mul_u32_u24 v22, 3456, v22
  v_add3_u32 v5, v22, v23, s33
  v_add_u32 v22, 8, v2
  v_xor_b32 v23, v22, v3
  v_lshlrev_b32 v23, 4, v23
  v_mul_u32_u24 v22, 3456, v22
  v_add3_u32 v6, v22, v23, s33
  v_add_u32 v22, 12, v2
  v_xor_b32 v23, v22, v3
  v_lshlrev_b32 v23, 4, v23
  v_mul_u32_u24 v22, 3456, v22
  v_add3_u32 v7, v22, v23, s33
  s_waitcnt lgkmcnt(0)
  s_add_u32 s4, s44, 0x900000
  s_addc_u32 s5, s45, 0
  s_mov_b32 s6, 0x6c0000
  s_mov_b32 s7, 0x20000
  s_add_u32 s8, s44, 0x1200000
  s_addc_u32 s9, s45, 0
  s_mov_b32 s10, 0x230000
  s_mov_b32 s11, 0x20000
  s_add_u32 s12, s44, 0x600000
  s_addc_u32 s13, s45, 0
  s_mov_b32 s14, 0x280000
  s_mov_b32 s15, 0x20000
  s_mov_b32 s16, s50
  s_mov_b32 s17, s51
  s_mov_b32 s18, 0x280000
  s_mov_b32 s19, 0x20000
  s_setprio 3
  s_mov_b32 s27, 0
  s_mov_b32 s28, 0
  s_mov_b32 s29, 0
  s_mov_b32 s55, 0
  s_mov_b32 s56, 0
L_k5_down_kernel_8:
  s_cmp_lt_u32 s56, 3
  s_cbranch_scc1 L_k5_down_kernel_9
  s_waitcnt vmcnt(32)
  s_barrier
L_k5_down_kernel_9:
  s_add_u32 m0, s55, 0
  s_add_u32 s33, s27, 0
  buffer_load_dwordx4 v4, s[4:7], s33 offen lds
  s_add_u32 m0, s55, 1024
  s_add_u32 s33, s27, 0
  buffer_load_dwordx4 v5, s[4:7], s33 offen lds
  s_add_u32 m0, s55, 2048
  s_add_u32 s33, s27, 0
  buffer_load_dwordx4 v6, s[4:7], s33 offen lds
  s_add_u32 m0, s55, 3072
  s_add_u32 s33, s27, 0
  buffer_load_dwordx4 v7, s[4:7], s33 offen lds
  s_add_u32 m0, s55, 4096
  s_add_u32 s33, s27, 55296
  buffer_load_dwordx4 v4, s[4:7], s33 offen lds
  s_add_u32 m0, s55, 5120
  s_add_u32 s33, s27, 55296
  buffer_load_dwordx4 v5, s[4:7], s33 offen lds
  s_add_u32 m0, s55, 6144
  s_add_u32 s33, s27, 55296
  buffer_load_dwordx4 v6, s[4:7], s33 offen lds
  s_add_u32 m0, s55, 7168
  s_add_u32 s33, s27, 55296
  buffer_load_dwordx4 v7, s[4:7], s33 offen lds
  s_add_u32 m0, s55, 8192
  s_add_u32 s33, s27, 110592
  buffer_load_dwordx4 v4, s[4:7], s33 offen lds
  s_add_u32 m0, s55, 9216
  s_add_u32 s33, s27, 110592
  buffer_load_dwordx4 v5, s[4:7], s33 offen lds
  s_add_u32 m0, s55, 10240
  s_add_u32 s33, s27, 110592
  buffer_load_dwordx4 v6, s[4:7], s33 offen lds
  s_add_u32 m0, s55, 11264
  s_add_u32 s33, s27, 110592
  buffer_load_dwordx4 v7, s[4:7], s33 offen lds
  s_add_u32 m0, s55, 12288
  s_add_u32 s33, s27, 165888
  buffer_load_dwordx4 v4, s[4:7], s33 offen lds
  s_add_u32 m0, s55, 13312
  s_add_u32 s33, s27, 165888
  buffer_load_dwordx4 v5, s[4:7], s33 offen lds
  s_add_u32 m0, s55, 14336
  s_add_u32 s33, s27, 165888
  buffer_load_dwordx4 v6, s[4:7], s33 offen lds
  s_add_u32 m0, s55, 15360
  s_add_u32 s33, s27, 165888
  buffer_load_dwordx4 v7, s[4:7], s33 offen lds
  s_add_u32 s27, s27, 256
  s_add_u32 s55, s55, 36864
  s_cmp_eq_u32 s55, 147456
  s_cselect_b32 s55, 0, s55
  s_add_u32 s56, s56, 1
  s_cmp_lt_u32 s56, 14
  s_cbranch_scc1 L_k5_down_kernel_8
  s_waitcnt vmcnt(32)
  s_barrier
  s_waitcnt vmcnt(16)
  s_barrier
  s_waitcnt vmcnt(0)
  s_barrier
  s_endpgm
L_k5_down_kernel_2:
  s_mul_i32 s33, s26, 286720
  v_lshlrev_b32 v22, 4, v1
  v_add_u32 v8, s33, v22
  v_add_u32 v9, 1024, v8
  v_add_u32 v10, 2048, v8
  v_add_u32 v11, 3072, v8
  v_add_u32 v12, 4096, v8
  s_waitcnt lgkmcnt(0)
  s_add_u32 s4, s44, 0x900000
  s_addc_u32 s5, s45, 0
  s_mov_b32 s6, 0x6c0000
  s_mov_b32 s7, 0x20000
  s_add_u32 s8, s44, 0x1200000
  s_addc_u32 s9, s45, 0
  s_mov_b32 s10, 0x230000
  s_mov_b32 s11, 0x20000
  s_add_u32 s12, s44, 0x600000
  s_addc_u32 s13, s45, 0
  s_mov_b32 s14, 0x280000
  s_mov_b32 s15, 0x20000
  s_mov_b32 s16, s50
  s_mov_b32 s17, s51
  s_mov_b32 s18, 0x280000
  s_mov_b32 s19, 0x20000
  s_setprio 3
  s_mov_b32 s27, 0
  s_mov_b32 s28, 0
  s_mov_b32 s29, 0
  s_mov_b32 s55, 0
  s_mov_b32 s56, 0
L_k5_down_kernel_11:
  s_cmp_lt_u32 s56, 3
  s_cbranch_scc1 L_k5_down_kernel_12
  s_waitcnt vmcnt(40)
  s_barrier
L_k5_down_kernel_12:
  s_add_u32 m0, s55, 16384
  s_add_u32 s33, s28, 0
  buffer_load_dwordx4 v8, s[8:11], s33 offen lds
  s_add_u32 m0, s55, 17408
  s_add_u32 s33, s28, 0
  buffer_load_dwordx4 v9, s[8:11], s33 offen lds
  s_add_u32 m0, s55, 18432
  s_add_u32 s33, s28, 0
  buffer_load_dwordx4 v10, s[8:11], s33 offen lds
  s_add_u32 m0, s55, 19456
  s_add_u32 s33, s28, 0
  buffer_load_dwordx4 v11, s[8:11], s33 offen lds
  s_add_u32 m0, s55, 20480
  s_add_u32 s33, s28, 0
  buffer_load_dwordx4 v12, s[8:11], s33 offen lds
  s_add_u32 m0, s55, 21504
  s_add_u32 s33, s28, 5120
  buffer_load_dwordx4 v8, s[8:11], s33 offen lds
  s_add_u32 m0, s55, 22528
  s_add_u32 s33, s28, 5120
  buffer_load_dwordx4 v9, s[8:11], s33 offen lds
  s_add_u32 m0, s55, 23552
  s_add_u32 s33, s28, 5120
  buffer_load_dwordx4 v10, s[8:11], s33 offen lds
  s_add_u32 m0, s55, 24576
  s_add_u32 s33, s28, 5120
  buffer_load_dwordx4 v11, s[8:11], s33 offen lds
  s_add_u32 m0, s55, 25600
  s_add_u32 s33, s28, 5120
  buffer_load_dwordx4 v12, s[8:11], s33 offen lds
  s_add_u32 m0, s55, 26624
  s_add_u32 s33, s28, 10240
  buffer_load_dwordx4 v8, s[8:11], s33 offen lds
  s_add_u32 m0, s55, 27648
  s_add_u32 s33, s28, 10240
  buffer_load_dwordx4 v9, s[8:11], s33 offen lds
  s_add_u32 m0, s55, 28672
  s_add_u32 s33, s28, 10240
  buffer_load_dwordx4 v10, s[8:11], s33 offen lds
  s_add_u32 m0, s55, 29696
  s_add_u32 s33, s28, 10240
  buffer_load_dwordx4 v11, s[8:11], s33 offen lds
  s_add_u32 m0, s55, 30720
  s_add_u32 s33, s28, 10240
  buffer_load_dwordx4 v12, s[8:11], s33 offen lds
  s_add_u32 m0, s55, 31744
  s_add_u32 s33, s28, 15360
  buffer_load_dwordx4 v8, s[8:11], s33 offen lds
  s_add_u32 m0, s55, 32768
  s_add_u32 s33, s28, 15360
  buffer_load_dwordx4 v9, s[8:11], s33 offen lds
  s_add_u32 m0, s55, 33792
  s_add_u32 s33, s28, 15360
  buffer_load_dwordx4 v10, s[8:11], s33 offen lds
  s_add_u32 m0, s55, 34816
  s_add_u32 s33, s28, 15360
  buffer_load_dwordx4 v11, s[8:11], s33 offen lds
  s_add_u32 m0, s55, 35840
  s_add_u32 s33, s28, 15360
  buffer_load_dwordx4 v12, s[8:11], s33 offen lds
  s_add_u32 s28, s28, 20480
  s_add_u32 s55, s55, 36864
  s_cmp_eq_u32 s55, 147456
  s_cselect_b32 s55, 0, s55
  s_add_u32 s56, s56, 1
  s_cmp_lt_u32 s56, 14
  s_cbranch_scc1 L_k5_down_kernel_11
  s_waitcnt vmcnt(40)
  s_barrier
  s_waitcnt vmcnt(20)
  s_barrier
  s_waitcnt vmcnt(0)
  s_barrier
  s_endpgm
L_k5_down_kernel_end:
  s_endpgm
.section .rodata,"a"
.p2align 6
.amdhsa_kernel k1_qkv_kernel
  .amdhsa_next_free_vgpr 144
  .amdhsa_next_free_sgpr 96
  .amdhsa_accum_offset 144
  .amdhsa_group_segment_fixed_size 0
  .amdhsa_kernarg_size 96
  .amdhsa_user_sgpr_count 2
  .amdhsa_user_sgpr_kernarg_segment_ptr 1
  .amdhsa_system_sgpr_workgroup_id_x 1
.end_amdhsa_kernel
.p2align 6
.amdhsa_kernel k2_attn_kernel
  .amdhsa_next_free_vgpr 112
  .amdhsa_next_free_sgpr 96
  .amdhsa_accum_offset 112
  .amdhsa_group_segment_fixed_size 0
  .amdhsa_kernarg_size 96
  .amdhsa_user_sgpr_count 2
  .amdhsa_user_sgpr_kernarg_segment_ptr 1
  .amdhsa_system_sgpr_workgroup_id_x 1
.end_amdhsa_kernel
.p2align 6
.amdhsa_kernel k3_wo_kernel
  .amdhsa_next_free_vgpr 144
  .amdhsa_next_free_sgpr 96
  .amdhsa_accum_offset 144
  .amdhsa_group_segment_fixed_size 0
  .amdhsa_kernarg_size 96
  .amdhsa_user_sgpr_count 2
  .amdhsa_user_sgpr_kernarg_segment_ptr 1
  .amdhsa_system_sgpr_workgroup_id_x 1
.end_amdhsa_kernel
.p2align 6
.amdhsa_kernel k4_gateup_kernel
  .amdhsa_next_free_vgpr 164
  .amdhsa_next_free_sgpr 96
  .amdhsa_accum_offset 164
  .amdhsa_group_segment_fixed_size 0
  .amdhsa_kernarg_size 96
  .amdhsa_user_sgpr_count 2
  .amdhsa_user_sgpr_kernarg_segment_ptr 1
  .amdhsa_system_sgpr_workgroup_id_x 1
.end_amdhsa_kernel
.p2align 6
.amdhsa_kernel k5_down_kernel
  .amdhsa_next_free_vgpr 144
  .amdhsa_next_free_sgpr 96
  .amdhsa_accum_offset 144
  .amdhsa_group_segment_fixed_size 0
  .amdhsa_kernarg_size 96
  .amdhsa_user_sgpr_count 2
  .amdhsa_user_sgpr_kernarg_segment_ptr 1
  .amdhsa_system_sgpr_workgroup_id_x 1
.end_amdhsa_kernel
```
